```python
import torch

def _softmax(x, axis=-1):
    return torch.softmax(x, dim=axis)

def _gelu(x):
    return torch.nn.functional.gelu(x, approximate='tanh')

def _silu(x):
    return torch.nn.functional.silu(x)

def _sigmoid(x):
    return torch.sigmoid(x)

def _layernorm(x, axis=-1, eps=1e-05):
    m = x.mean(dim=axis, keepdim=True)
    v = x.var(dim=axis, keepdim=True, unbiased=False)
    return (x - m) / torch.sqrt(v + eps)

def _scatter_add(tgt, idx, src, axis=0):
    return tgt.clone().index_add_(axis, idx, src)

def _segment_sum(src, seg, n):
    out = torch.zeros((n,) + src.shape[1:], dtype=src.dtype)
    return out.index_add_(0, seg, src)

def _pad(x, pw):
    flat = tuple((v for pair in reversed(pw) for v in pair))
    return torch.nn.functional.pad(x, flat)
kernel_name = 'adaLN_cond__spectral_fnet__geglu_ffn__prompt'

def setup_inputs():

    _w = lambda a: (lambda t: t.to(torch.bfloat16) if t.is_floating_point() else t)(torch.as_tensor(a))

    def _A_setup():
        B, S, D = (1, 2048, 512)
        ns = torch.arange(S)[:, None] * torch.arange(S)[None, :]
        nd = torch.arange(D)[:, None] * torch.arange(D)[None, :]
        Ws_re = torch.cos(-2.0 * torch.pi * ns / S).to(float)
        Ws_im = torch.sin(-2.0 * torch.pi * ns / S).to(float)
        Wd_re = torch.cos(-2.0 * torch.pi * nd / D).to(float)
        Wd_im = torch.sin(-2.0 * torch.pi * nd / D).to(float)
        return {'x': _w((lambda *s: torch.randn(*s, dtype=torch.bfloat16) * 0.05)(B, S, D)), 'dft_seq_re': _w(Ws_re), 'dft_seq_im': _w(Ws_im), 'dft_hid_re': _w(Wd_re), 'dft_hid_im': _w(Wd_im)}
    _A_in = _A_setup()

    def _B_setup():
        B, S, D, F = (1, 2048, 512, 1792)
        return {'x': _w((lambda *s: torch.randn(*s, dtype=torch.bfloat16) * 0.05)(B, S, D)), 'w_gate': _w((lambda *s: torch.randn(*s, dtype=torch.bfloat16) * 0.4)(D, F)), 'w_up': _w((lambda *s: torch.randn(*s, dtype=torch.bfloat16) * 0.4)(D, F)), 'w_down': _w((lambda *s: torch.randn(*s, dtype=torch.bfloat16) * 0.4)(F, D))}
    _B_in = _B_setup()
    return {'A_x': _A_in['x'], 'A_dft_seq_re': _A_in['dft_seq_re'], 'A_dft_seq_im': _A_in['dft_seq_im'], 'A_dft_hid_re': _A_in['dft_hid_re'], 'A_dft_hid_im': _A_in['dft_hid_im'], 'B_x': _B_in['x'], 'B_w_gate': _B_in['w_gate'], 'B_w_up': _B_in['w_up'], 'B_w_down': _B_in['w_down'], 'c': _w((lambda *s: torch.randn(*s, dtype=torch.bfloat16) * 0.2)(1, 512) * 8.0), 'w_mod': _w((lambda *s: torch.randn(*s, dtype=torch.bfloat16) * 0.2)(512, 6 * 512) * 512 ** (-0.5) * 8.0)}

def reference(A_x, A_dft_seq_re, A_dft_seq_im, A_dft_hid_re, A_dft_hid_im, B_x, B_w_gate, B_w_up, B_w_down, c, w_mod):

    def _A_ref(x, dft_seq_re, dft_seq_im, dft_hid_re, dft_hid_im):
        a = torch.einsum('bsd,ed->bse', x, dft_hid_re)
        b = torch.einsum('bsd,ed->bse', x, dft_hid_im)
        y = torch.einsum('ts,bse->bte', dft_seq_re, a) - torch.einsum('ts,bse->bte', dft_seq_im, b)
        return y

    def _B_ref(x, w_gate, w_up, w_down):
        return _gelu(x @ w_gate) * (x @ w_up) @ w_down
    x = A_x
    mod = (_silu(c) @ w_mod).reshape(c.shape[0], 6, 1, -1)
    sa, ca, ga, sb, cb, gb = (mod[:, 0].clone(), mod[:, 1].clone(), mod[:, 2].clone(), mod[:, 3].clone(), mod[:, 4].clone(), mod[:, 5].clone())
    h = _layernorm(x, axis=-1) * (1 + ca) + sa
    x = x + ga * _A_ref(h, A_dft_seq_re, A_dft_seq_im, A_dft_hid_re, A_dft_hid_im)
    h = _layernorm(x, axis=-1) * (1 + cb) + sb
    x = x + gb * _B_ref(h, B_w_gate, B_w_up, B_w_down)
    return x
```

```asm
; @launch grid=(256,1,1) block=(512,1,1) lds=158016
.amdgcn_target "amdgcn-amd-amdhsa--gfx950"
.text
.globl adaLN_cond__spectral_fnet__geglu_ffn__prompt_kernel
.p2align 8
.type adaLN_cond__spectral_fnet__geglu_ffn__prompt_kernel,@function
adaLN_cond__spectral_fnet__geglu_ffn__prompt_kernel:
    s_cmp_ge_u32 s2, 256
    s_cbranch_scc1 KC_end
    s_load_dwordx2 s[4:5], s[0:1], 104
    s_load_dwordx2 s[66:67], s[0:1], 96
    s_getpc_b64 s[26:27]
K1_pc:
    v_lshlrev_b32 v1, 6, v0
    s_cmp_lt_u32 s2, 8
    s_cbranch_scc0 K1_pfskip
    v_cmp_gt_u32 vcc, KC_code_end-K1_pc-4, v1
    s_nop 0
    s_and_saveexec_b64 s[28:29], vcc
    s_cbranch_execz K1_pfr
    global_load_dword v127, v1, s[26:27]
K1_pfr:
    s_mov_b64 exec, -1
K1_pfskip:
    v_lshrrev_b32 v1, 6, v0
    s_nop 0
    v_readfirstlane_b32 s65, v1
    s_mov_b32 s64, 0x10000
    s_cmp_ge_u32 s2, 160
    s_cbranch_scc1 K1_rel
    s_cmp_ge_u32 s2, 64
    s_cbranch_scc1 K1_gemv
    s_load_dwordx2 s[6:7], s[0:1], 0
    s_and_b32 s16, s2, 31
    s_lshr_b32 s17, s2, 5
    s_lshl_b32 s18, s17, 9
    s_xor_b32 s20, s18, 512
    s_lshl_b32 s21, s17, 5
    v_lshrrev_b32 v1, 3, v0
    v_xor_b32 v1, s21, v1
    v_and_b32 v2, 7, v0
    v_lshlrev_b32 v2, 4, v2
    v_lshl_add_u32 v3, v1, 15, v2
    s_lshl_b32 s19, s16, 10
    v_add_u32 v3, s19, v3
    s_waitcnt lgkmcnt(0)
    s_mov_b32 s8, s6
    s_mov_b32 s9, s7
    s_mov_b32 s10, 0x200000
    s_mov_b32 s11, 0x20000
    buffer_load_dwordx4 v[32:35], v3, s[8:11], s18 offen offset:0 nt
    buffer_load_dwordx4 v[36:39], v3, s[8:11], s18 offen offset:128 nt
    buffer_load_dwordx4 v[40:43], v3, s[8:11], s18 offen offset:256 nt
    buffer_load_dwordx4 v[44:47], v3, s[8:11], s18 offen offset:384 nt
    buffer_load_dwordx4 v[48:51], v3, s[8:11], s20 offen offset:0 nt
    buffer_load_dwordx4 v[52:55], v3, s[8:11], s20 offen offset:128 nt
    buffer_load_dwordx4 v[56:59], v3, s[8:11], s20 offen offset:256 nt
    buffer_load_dwordx4 v[60:63], v3, s[8:11], s20 offen offset:384 nt
    s_mov_b32 s12, s4
    s_mov_b32 s13, s5
    s_mov_b32 s14, 0x200000
    s_mov_b32 s15, 0x20000
    v_mul_u32_u24 v4, 576, v1
    v_add_u32 v4, v4, v2
    v_and_b32 v5, 63, v0
    v_lshrrev_b32 v6, 6, v0
    v_and_b32 v7, 31, v5
    v_lshrrev_b32 v8, 5, v5
    v_and_b32 v9, 3, v6
    v_lshrrev_b32 v10, 2, v6
    v_cmp_eq_u32 vcc, 0, v7
    s_nop 1
    v_cndmask_b32 v11, v7, 32, vcc
    v_mov_b32 v12, 0x3e800000
    v_cndmask_b32 v12, v12, 0, vcc
    v_cmp_eq_u32 vcc, 0, v10
    s_nop 1
    v_cndmask_b32 v11, v11, v7, vcc
    v_cndmask_b32 v12, v12, 0, vcc
    v_cvt_f32_u32 v11, v11
    v_mul_f32 v11, 0x3c800000, v11
    v_lshlrev_b32 v13, 3, v8
    v_cvt_f32_u32 v13, v13
    v_fma_f32 v12, v11, v13, v12
    v_fmamk_f32 v80, v11, 0x00000000, v12
    v_fmamk_f32 v81, v11, 0x3f800000, v12
    v_fmamk_f32 v82, v11, 0x40000000, v12
    v_fmamk_f32 v83, v11, 0x40400000, v12
    v_fmamk_f32 v84, v11, 0x40800000, v12
    v_fmamk_f32 v85, v11, 0x40a00000, v12
    v_fmamk_f32 v86, v11, 0x40c00000, v12
    v_fmamk_f32 v87, v11, 0x40e00000, v12
    v_cos_f32 v80, v80
    v_cos_f32 v81, v81
    v_cos_f32 v82, v82
    v_cos_f32 v83, v83
    v_cos_f32 v84, v84
    v_cos_f32 v85, v85
    v_cos_f32 v86, v86
    v_cos_f32 v87, v87
    v_cvt_pk_f16_f32 v64, v80, v81
    v_cvt_pk_f16_f32 v65, v82, v83
    v_cvt_pk_f16_f32 v66, v84, v85
    v_cvt_pk_f16_f32 v67, v86, v87
    v_fmamk_f32 v80, v11, 0x41800000, v12
    v_fmamk_f32 v81, v11, 0x41880000, v12
    v_fmamk_f32 v82, v11, 0x41900000, v12
    v_fmamk_f32 v83, v11, 0x41980000, v12
    v_fmamk_f32 v84, v11, 0x41a00000, v12
    v_fmamk_f32 v85, v11, 0x41a80000, v12
    v_fmamk_f32 v86, v11, 0x41b00000, v12
    v_fmamk_f32 v87, v11, 0x41b80000, v12
    v_cos_f32 v80, v80
    v_cos_f32 v81, v81
    v_cos_f32 v82, v82
    v_cos_f32 v83, v83
    v_cos_f32 v84, v84
    v_cos_f32 v85, v85
    v_cos_f32 v86, v86
    v_cos_f32 v87, v87
    v_cvt_pk_f16_f32 v68, v80, v81
    v_cvt_pk_f16_f32 v69, v82, v83
    v_cvt_pk_f16_f32 v70, v84, v85
    v_cvt_pk_f16_f32 v71, v86, v87
    v_fmamk_f32 v80, v11, 0x42000000, v12
    v_fmamk_f32 v81, v11, 0x42040000, v12
    v_fmamk_f32 v82, v11, 0x42080000, v12
    v_fmamk_f32 v83, v11, 0x420c0000, v12
    v_fmamk_f32 v84, v11, 0x42100000, v12
    v_fmamk_f32 v85, v11, 0x42140000, v12
    v_fmamk_f32 v86, v11, 0x42180000, v12
    v_fmamk_f32 v87, v11, 0x421c0000, v12
    v_cos_f32 v80, v80
    v_cos_f32 v81, v81
    v_cos_f32 v82, v82
    v_cos_f32 v83, v83
    v_cos_f32 v84, v84
    v_cos_f32 v85, v85
    v_cos_f32 v86, v86
    v_cos_f32 v87, v87
    v_cvt_pk_f16_f32 v72, v80, v81
    v_cvt_pk_f16_f32 v73, v82, v83
    v_cvt_pk_f16_f32 v74, v84, v85
    v_cvt_pk_f16_f32 v75, v86, v87
    v_fmamk_f32 v80, v11, 0x42400000, v12
    v_fmamk_f32 v81, v11, 0x42440000, v12
    v_fmamk_f32 v82, v11, 0x42480000, v12
    v_fmamk_f32 v83, v11, 0x424c0000, v12
    v_fmamk_f32 v84, v11, 0x42500000, v12
    v_fmamk_f32 v85, v11, 0x42540000, v12
    v_fmamk_f32 v86, v11, 0x42580000, v12
    v_fmamk_f32 v87, v11, 0x425c0000, v12
    v_cos_f32 v80, v80
    v_cos_f32 v81, v81
    v_cos_f32 v82, v82
    v_cos_f32 v83, v83
    v_cos_f32 v84, v84
    v_cos_f32 v85, v85
    v_cos_f32 v86, v86
    v_cos_f32 v87, v87
    v_cvt_pk_f16_f32 v76, v80, v81
    v_cvt_pk_f16_f32 v77, v82, v83
    v_cvt_pk_f16_f32 v78, v84, v85
    v_cvt_pk_f16_f32 v79, v86, v87
    v_and_b32 v14, 15, v5
    v_lshrrev_b32 v15, 2, v14
    v_lshl_add_u32 v15, v8, 3, v15
    v_mul_u32_u24 v15, 576, v15
    v_bfe_u32 v16, v5, 4, 1
    v_lshlrev_b32 v16, 2, v16
    v_and_b32 v17, 1, v14
    v_lshl_or_b32 v16, v17, 1, v16
    v_bfe_u32 v17, v14, 1, 1
    v_or_b32 v16, v16, v17
    v_lshlrev_b32 v16, 3, v16
    v_lshl_add_u32 v16, v9, 7, v16
    v_add_u32 v15, v15, v16
    v_lshl_add_u32 v18, v7, 1, v10
    v_lshlrev_b32 v18, 15, v18
    v_lshl_add_u32 v18, v9, 7, v18
    v_lshl_add_u32 v18, v8, 4, v18
    s_add_u32 s18, s18, s19
    s_call_b64 s[62:63], KC_pre
K1_npre:
    v_mov_b32 v20, 0
    v_mov_b32 v21, 0
    v_mov_b32 v22, 0
    v_mov_b32 v23, 0
    s_mov_b32 s30, 0x3f803f80
    s_waitcnt vmcnt(7)
    v_dot2c_f32_bf16 v20, s30, v32
    v_dot2c_f32_bf16 v22, v32, v32
    v_dot2c_f32_bf16 v21, s30, v33
    v_dot2c_f32_bf16 v23, v33, v33
    v_dot2c_f32_bf16 v20, s30, v34
    v_dot2c_f32_bf16 v22, v34, v34
    v_dot2c_f32_bf16 v21, s30, v35
    v_dot2c_f32_bf16 v23, v35, v35
    s_waitcnt vmcnt(6)
    v_dot2c_f32_bf16 v20, s30, v36
    v_dot2c_f32_bf16 v22, v36, v36
    v_dot2c_f32_bf16 v21, s30, v37
    v_dot2c_f32_bf16 v23, v37, v37
    v_dot2c_f32_bf16 v20, s30, v38
    v_dot2c_f32_bf16 v22, v38, v38
    v_dot2c_f32_bf16 v21, s30, v39
    v_dot2c_f32_bf16 v23, v39, v39
    s_waitcnt vmcnt(5)
    v_dot2c_f32_bf16 v20, s30, v40
    v_dot2c_f32_bf16 v22, v40, v40
    v_dot2c_f32_bf16 v21, s30, v41
    v_dot2c_f32_bf16 v23, v41, v41
    v_dot2c_f32_bf16 v20, s30, v42
    v_dot2c_f32_bf16 v22, v42, v42
    v_dot2c_f32_bf16 v21, s30, v43
    v_dot2c_f32_bf16 v23, v43, v43
    s_waitcnt vmcnt(4)
    v_dot2c_f32_bf16 v20, s30, v44
    v_dot2c_f32_bf16 v22, v44, v44
    v_dot2c_f32_bf16 v21, s30, v45
    v_dot2c_f32_bf16 v23, v45, v45
    v_dot2c_f32_bf16 v20, s30, v46
    v_dot2c_f32_bf16 v22, v46, v46
    v_dot2c_f32_bf16 v21, s30, v47
    v_dot2c_f32_bf16 v23, v47, v47
    s_waitcnt vmcnt(3)
    v_dot2c_f32_bf16 v20, s30, v48
    v_dot2c_f32_bf16 v22, v48, v48
    v_dot2c_f32_bf16 v21, s30, v49
    v_dot2c_f32_bf16 v23, v49, v49
    v_dot2c_f32_bf16 v20, s30, v50
    v_dot2c_f32_bf16 v22, v50, v50
    v_dot2c_f32_bf16 v21, s30, v51
    v_dot2c_f32_bf16 v23, v51, v51
    s_waitcnt vmcnt(2)
    v_dot2c_f32_bf16 v20, s30, v52
    v_dot2c_f32_bf16 v22, v52, v52
    v_dot2c_f32_bf16 v21, s30, v53
    v_dot2c_f32_bf16 v23, v53, v53
    v_dot2c_f32_bf16 v20, s30, v54
    v_dot2c_f32_bf16 v22, v54, v54
    v_dot2c_f32_bf16 v21, s30, v55
    v_dot2c_f32_bf16 v23, v55, v55
    s_waitcnt vmcnt(1)
    v_dot2c_f32_bf16 v20, s30, v56
    v_dot2c_f32_bf16 v22, v56, v56
    v_dot2c_f32_bf16 v21, s30, v57
    v_dot2c_f32_bf16 v23, v57, v57
    v_dot2c_f32_bf16 v20, s30, v58
    v_dot2c_f32_bf16 v22, v58, v58
    v_dot2c_f32_bf16 v21, s30, v59
    v_dot2c_f32_bf16 v23, v59, v59
    s_waitcnt vmcnt(0)
    v_dot2c_f32_bf16 v20, s30, v60
    v_dot2c_f32_bf16 v22, v60, v60
    v_dot2c_f32_bf16 v21, s30, v61
    v_dot2c_f32_bf16 v23, v61, v61
    v_dot2c_f32_bf16 v20, s30, v62
    v_dot2c_f32_bf16 v22, v62, v62
    v_dot2c_f32_bf16 v21, s30, v63
    v_dot2c_f32_bf16 v23, v63, v63
    s_nop 1
    v_add_f32 v20, v20, v21
    v_add_f32 v22, v22, v23
    s_nop 0
    v_add_f32_dpp v20, v20, v20 quad_perm:[1,0,3,2] row_mask:0xf bank_mask:0xf
    v_add_f32_dpp v22, v22, v22 quad_perm:[1,0,3,2] row_mask:0xf bank_mask:0xf
    s_nop 0
    v_add_f32_dpp v20, v20, v20 quad_perm:[2,3,0,1] row_mask:0xf bank_mask:0xf
    v_add_f32_dpp v22, v22, v22 quad_perm:[2,3,0,1] row_mask:0xf bank_mask:0xf
    s_nop 0
    v_add_f32_dpp v20, v20, v20 row_half_mirror row_mask:0xf bank_mask:0xf
    v_add_f32_dpp v22, v22, v22 row_half_mirror row_mask:0xf bank_mask:0xf
    v_mul_f32 v20, 0x3b000000, v20
    v_mul_f32 v22, 0x3b000000, v22
    v_fma_f32 v22, -v20, v20, v22
    v_max_f32 v22, 0, v22
    v_add_f32 v22, 0x3727c5ac, v22
    v_rsq_f32 v22, v22
    s_nop 0
    v_mul_f32 v20, v20, v22
    v_mov_b32 v23, v22
    v_sub_f32 v20, 0, v20
    v_mov_b32 v21, v20
    s_mov_b32 s31, 0xffff0000
    v_lshlrev_b32 v24, 16, v32
    v_and_b32 v25, s31, v32
    v_lshlrev_b32 v26, 16, v33
    v_and_b32 v27, s31, v33
    v_lshlrev_b32 v28, 16, v34
    v_and_b32 v29, s31, v34
    v_lshlrev_b32 v30, 16, v35
    v_and_b32 v31, s31, v35
    v_pk_fma_f32 v[24:25], v[24:25], v[22:23], v[20:21]
    v_pk_fma_f32 v[26:27], v[26:27], v[22:23], v[20:21]
    v_pk_fma_f32 v[28:29], v[28:29], v[22:23], v[20:21]
    v_pk_fma_f32 v[30:31], v[30:31], v[22:23], v[20:21]
    v_cvt_pk_f16_f32 v32, v24, v25
    v_cvt_pk_f16_f32 v33, v26, v27
    v_cvt_pk_f16_f32 v34, v28, v29
    v_cvt_pk_f16_f32 v35, v30, v31
    ds_write_b128 v4, v[32:35] offset:0
    v_lshlrev_b32 v24, 16, v36
    v_and_b32 v25, s31, v36
    v_lshlrev_b32 v26, 16, v37
    v_and_b32 v27, s31, v37
    v_lshlrev_b32 v28, 16, v38
    v_and_b32 v29, s31, v38
    v_lshlrev_b32 v30, 16, v39
    v_and_b32 v31, s31, v39
    v_pk_fma_f32 v[24:25], v[24:25], v[22:23], v[20:21]
    v_pk_fma_f32 v[26:27], v[26:27], v[22:23], v[20:21]
    v_pk_fma_f32 v[28:29], v[28:29], v[22:23], v[20:21]
    v_pk_fma_f32 v[30:31], v[30:31], v[22:23], v[20:21]
    v_cvt_pk_f16_f32 v36, v24, v25
    v_cvt_pk_f16_f32 v37, v26, v27
    v_cvt_pk_f16_f32 v38, v28, v29
    v_cvt_pk_f16_f32 v39, v30, v31
    ds_write_b128 v4, v[36:39] offset:128
    v_lshlrev_b32 v24, 16, v40
    v_and_b32 v25, s31, v40
    v_lshlrev_b32 v26, 16, v41
    v_and_b32 v27, s31, v41
    v_lshlrev_b32 v28, 16, v42
    v_and_b32 v29, s31, v42
    v_lshlrev_b32 v30, 16, v43
    v_and_b32 v31, s31, v43
    v_pk_fma_f32 v[24:25], v[24:25], v[22:23], v[20:21]
    v_pk_fma_f32 v[26:27], v[26:27], v[22:23], v[20:21]
    v_pk_fma_f32 v[28:29], v[28:29], v[22:23], v[20:21]
    v_pk_fma_f32 v[30:31], v[30:31], v[22:23], v[20:21]
    v_cvt_pk_f16_f32 v40, v24, v25
    v_cvt_pk_f16_f32 v41, v26, v27
    v_cvt_pk_f16_f32 v42, v28, v29
    v_cvt_pk_f16_f32 v43, v30, v31
    ds_write_b128 v4, v[40:43] offset:256
    v_lshlrev_b32 v24, 16, v44
    v_and_b32 v25, s31, v44
    v_lshlrev_b32 v26, 16, v45
    v_and_b32 v27, s31, v45
    v_lshlrev_b32 v28, 16, v46
    v_and_b32 v29, s31, v46
    v_lshlrev_b32 v30, 16, v47
    v_and_b32 v31, s31, v47
    v_pk_fma_f32 v[24:25], v[24:25], v[22:23], v[20:21]
    v_pk_fma_f32 v[26:27], v[26:27], v[22:23], v[20:21]
    v_pk_fma_f32 v[28:29], v[28:29], v[22:23], v[20:21]
    v_pk_fma_f32 v[30:31], v[30:31], v[22:23], v[20:21]
    v_cvt_pk_f16_f32 v44, v24, v25
    v_cvt_pk_f16_f32 v45, v26, v27
    v_cvt_pk_f16_f32 v46, v28, v29
    v_cvt_pk_f16_f32 v47, v30, v31
    ds_write_b128 v4, v[44:47] offset:384
    s_waitcnt lgkmcnt(0)
    s_barrier
    ds_read_b64_tr_b16 v[32:33], v15 offset:0
    ds_read_b64_tr_b16 v[34:35], v15 offset:2304
    ds_read_b64_tr_b16 v[36:37], v15 offset:9216
    ds_read_b64_tr_b16 v[38:39], v15 offset:11520
    ds_read_b64_tr_b16 v[40:41], v15 offset:18432
    ds_read_b64_tr_b16 v[42:43], v15 offset:20736
    ds_read_b64_tr_b16 v[44:45], v15 offset:27648
    ds_read_b64_tr_b16 v[46:47], v15 offset:29952
    ds_read_b64_tr_b16 v[48:49], v15 offset:64
    ds_read_b64_tr_b16 v[50:51], v15 offset:2368
    ds_read_b64_tr_b16 v[52:53], v15 offset:9280
    ds_read_b64_tr_b16 v[54:55], v15 offset:11584
    ds_read_b64_tr_b16 v[56:57], v15 offset:18496
    ds_read_b64_tr_b16 v[58:59], v15 offset:20800
    ds_read_b64_tr_b16 v[60:61], v15 offset:27712
    ds_read_b64_tr_b16 v[62:63], v15 offset:30016
    s_waitcnt lgkmcnt(14)
    v_mfma_f32_32x32x16_f16 v[96:111], v[32:35], v[64:67], 0
    s_waitcnt lgkmcnt(12)
    v_mfma_f32_32x32x16_f16 v[96:111], v[36:39], v[68:71], v[96:111]
    s_waitcnt lgkmcnt(10)
    v_mfma_f32_32x32x16_f16 v[96:111], v[40:43], v[72:75], v[96:111]
    s_waitcnt lgkmcnt(8)
    v_mfma_f32_32x32x16_f16 v[96:111], v[44:47], v[76:79], v[96:111]
    s_waitcnt lgkmcnt(6)
    v_mfma_f32_32x32x16_f16 v[112:127], v[48:51], v[64:67], 0
    s_waitcnt lgkmcnt(4)
    v_mfma_f32_32x32x16_f16 v[112:127], v[52:55], v[68:71], v[112:127]
    s_waitcnt lgkmcnt(2)
    v_mfma_f32_32x32x16_f16 v[112:127], v[56:59], v[72:75], v[112:127]
    s_waitcnt lgkmcnt(0)
    v_mfma_f32_32x32x16_f16 v[112:127], v[60:63], v[76:79], v[112:127]
    v_mul_u32_u24 v19, 144, v7
    v_lshl_add_u32 v19, v8, 4, v19
    v_mul_u32_u24 v20, 4608, v6
    v_add_u32 v20, 36864, v20
    v_add_u32 v19, v19, v20
    v_lshrrev_b32 v21, 3, v5
    v_mul_u32_u24 v22, 144, v21
    v_add3_u32 v22, v22, v20, v2
    v_lshl_add_u32 v18, v21, 1, v10
    v_lshlrev_b32 v18, 15, v18
    v_lshl_add_u32 v18, v9, 7, v18
    v_add_u32 v18, v18, v2
    v_cvt_pk_f16_f32 v80, v96, v97
    v_cvt_pk_f16_f32 v81, v98, v99
    v_cvt_pk_f16_f32 v82, v100, v101
    v_cvt_pk_f16_f32 v83, v102, v103
    v_cvt_pk_f16_f32 v84, v104, v105
    v_cvt_pk_f16_f32 v85, v106, v107
    v_cvt_pk_f16_f32 v86, v108, v109
    v_cvt_pk_f16_f32 v87, v110, v111
    ds_write_b128 v19, v[80:83] offset:0
    ds_write_b128 v19, v[84:87] offset:32
    v_cvt_pk_f16_f32 v88, v112, v113
    v_cvt_pk_f16_f32 v89, v114, v115
    v_cvt_pk_f16_f32 v90, v116, v117
    v_cvt_pk_f16_f32 v91, v118, v119
    v_cvt_pk_f16_f32 v92, v120, v121
    v_cvt_pk_f16_f32 v93, v122, v123
    v_cvt_pk_f16_f32 v94, v124, v125
    v_cvt_pk_f16_f32 v95, v126, v127
    ds_write_b128 v19, v[88:91] offset:64
    ds_write_b128 v19, v[92:95] offset:96
    ds_read_b128 v[32:35], v22 offset:0
    ds_read_b128 v[36:39], v22 offset:1152
    ds_read_b128 v[40:43], v22 offset:2304
    ds_read_b128 v[44:47], v22 offset:3456
    s_waitcnt lgkmcnt(3)
    buffer_store_dwordx4 v[32:35], v18, s[12:15], s18 offen sc1
    s_add_u32 s18, s18, 0x80000
    s_waitcnt lgkmcnt(2)
    buffer_store_dwordx4 v[36:39], v18, s[12:15], s18 offen sc1
    s_add_u32 s18, s18, 0x80000
    s_waitcnt lgkmcnt(1)
    buffer_store_dwordx4 v[40:43], v18, s[12:15], s18 offen sc1
    s_add_u32 s18, s18, 0x80000
    s_waitcnt lgkmcnt(0)
    buffer_store_dwordx4 v[44:47], v18, s[12:15], s18 offen sc1
    s_branch K1_arrive
K1_gemv:
    s_sub_u32 s3, s2, 64
K1_gv0:
    s_load_dwordx4 s[16:19], s[0:1], 72
    s_and_b32 s24, s3, 7
    s_lshl_b32 s24, s24, 1
    s_bfe_u32 s25, s3, 0x10003
    s_add_u32 s24, s24, s25
    s_andn2_b32 s3, s3, 15
    s_add_u32 s3, s3, s24
    v_lshrrev_b32 v1, 2, v0
    v_and_b32 v2, 3, v0
    v_mul_u32_u24 v3, 49152, v1
    v_lshl_add_u32 v3, v2, 4, v3
    s_lshl_b32 s40, s3, 6
    s_add_u32 s41, s40, 6144
    s_add_u32 s42, s41, 6144
    s_add_u32 s43, s42, 6144
    s_add_u32 s44, s43, 6144
    s_add_u32 s45, s44, 6144
    s_add_u32 s46, s45, 6144
    s_add_u32 s47, s46, 6144
    v_lshlrev_b32 v4, 4, v1
    s_waitcnt lgkmcnt(0)
    s_mov_b32 s8, s18
    s_mov_b32 s9, s19
    s_mov_b32 s10, 0x300000
    s_mov_b32 s11, 0x20000
    s_mov_b32 s12, s16
    s_mov_b32 s13, s17
    s_mov_b32 s14, 0x400
    s_mov_b32 s15, 0x20000
    s_cmp_lt_u32 s65, 4
    s_cbranch_scc0 K1_gvnl
    buffer_load_dwordx4 v[12:15], v4, s[12:15], 0 offen
    buffer_load_dwordx4 v[32:35], v3, s[8:11], s40 offen nt
    buffer_load_dwordx4 v[36:39], v3, s[8:11], s41 offen nt
    buffer_load_dwordx4 v[40:43], v3, s[8:11], s42 offen nt
    buffer_load_dwordx4 v[44:47], v3, s[8:11], s43 offen nt
    buffer_load_dwordx4 v[48:51], v3, s[8:11], s44 offen nt
    buffer_load_dwordx4 v[52:55], v3, s[8:11], s45 offen nt
    buffer_load_dwordx4 v[56:59], v3, s[8:11], s46 offen nt
    buffer_load_dwordx4 v[60:63], v3, s[8:11], s47 offen nt
K1_gvnl:
    s_mov_b32 s12, s4
    s_mov_b32 s13, s5
    s_mov_b32 s14, 0x300000
    s_mov_b32 s15, 0x20000
    v_and_b32 v6, 63, v0
    v_lshrrev_b32 v5, 4, v0
    v_lshlrev_b32 v5, 7, v5
    v_lshl_add_u32 v5, v2, 5, v5
    v_and_b32 v7, 31, v0
    v_bfe_u32 v8, v0, 5, 1
    v_lshlrev_b32 v8, 10, v8
    v_lshl_add_u32 v8, v7, 2, v8
    v_mov_b32 v64, 0
    v_mov_b32 v65, 0
    v_mov_b32 v66, 0
    v_mov_b32 v67, 0
    v_mov_b32 v68, 0
    v_mov_b32 v69, 0
    v_mov_b32 v70, 0
    v_mov_b32 v71, 0
    s_cmp_lt_u32 s3, 16
    s_cbranch_scc0 K1_nocos
    v_lshrrev_b32 v9, 6, v0
    v_lshl_add_u32 v9, v9, 5, v7
    v_cmp_eq_u32 vcc, 32, v0
    v_mov_b32 v10, 0x100
    s_nop 0
    v_cndmask_b32 v9, v9, v10, vcc
    v_cvt_f32_u32 v9, v9
    v_mul_f32 v9, 0x3b000000, v9
    s_lshl_b32 s24, s3, 5
    v_cvt_f32_u32 v10, s24
    v_mul_f32 v10, v9, v10
    v_fmamk_f32 v80, v9, 0x00000000, v10
    v_fmamk_f32 v81, v9, 0x3f800000, v10
    v_fmamk_f32 v82, v9, 0x40000000, v10
    v_fmamk_f32 v83, v9, 0x40400000, v10
    v_fmamk_f32 v84, v9, 0x40800000, v10
    v_fmamk_f32 v85, v9, 0x40a00000, v10
    v_fmamk_f32 v86, v9, 0x40c00000, v10
    v_fmamk_f32 v87, v9, 0x40e00000, v10
    v_fmamk_f32 v88, v9, 0x41000000, v10
    v_fmamk_f32 v89, v9, 0x41100000, v10
    v_fmamk_f32 v90, v9, 0x41200000, v10
    v_fmamk_f32 v91, v9, 0x41300000, v10
    v_fmamk_f32 v92, v9, 0x41400000, v10
    v_fmamk_f32 v93, v9, 0x41500000, v10
    v_fmamk_f32 v94, v9, 0x41600000, v10
    v_fmamk_f32 v95, v9, 0x41700000, v10
    v_fmamk_f32 v96, v9, 0x41800000, v10
    v_fmamk_f32 v97, v9, 0x41880000, v10
    v_fmamk_f32 v98, v9, 0x41900000, v10
    v_fmamk_f32 v99, v9, 0x41980000, v10
    v_fmamk_f32 v100, v9, 0x41a00000, v10
    v_fmamk_f32 v101, v9, 0x41a80000, v10
    v_fmamk_f32 v102, v9, 0x41b00000, v10
    v_fmamk_f32 v103, v9, 0x41b80000, v10
    v_fmamk_f32 v104, v9, 0x41c00000, v10
    v_fmamk_f32 v105, v9, 0x41c80000, v10
    v_fmamk_f32 v106, v9, 0x41d00000, v10
    v_fmamk_f32 v107, v9, 0x41d80000, v10
    v_fmamk_f32 v108, v9, 0x41e00000, v10
    v_fmamk_f32 v109, v9, 0x41e80000, v10
    v_fmamk_f32 v110, v9, 0x41f00000, v10
    v_fmamk_f32 v111, v9, 0x41f80000, v10
    v_cos_f32 v80, v80
    v_cos_f32 v81, v81
    v_cos_f32 v82, v82
    v_cos_f32 v83, v83
    v_cos_f32 v84, v84
    v_cos_f32 v85, v85
    v_cos_f32 v86, v86
    v_cos_f32 v87, v87
    v_cos_f32 v88, v88
    v_cos_f32 v89, v89
    v_cos_f32 v90, v90
    v_cos_f32 v91, v91
    v_cos_f32 v92, v92
    v_cos_f32 v93, v93
    v_cos_f32 v94, v94
    v_cos_f32 v95, v95
    v_cos_f32 v96, v96
    v_cos_f32 v97, v97
    v_cos_f32 v98, v98
    v_cos_f32 v99, v99
    v_cos_f32 v100, v100
    v_cos_f32 v101, v101
    v_cos_f32 v102, v102
    v_cos_f32 v103, v103
    v_cos_f32 v104, v104
    v_cos_f32 v105, v105
    v_cos_f32 v106, v106
    v_cos_f32 v107, v107
    v_cos_f32 v108, v108
    v_cos_f32 v109, v109
    v_cos_f32 v110, v110
    v_cos_f32 v111, v111
K1_nocos:
    s_call_b64 s[62:63], KC_pre
    s_cmp_eq_u32 s65, 4
    s_cbranch_scc0 K1_nosn
    s_lshr_b32 s24, s3, 4
    s_cmp_eq_u32 s24, 1
    s_cbranch_scc0 K1_nosn
    s_mov_b32 s24, 30000
    v_mov_b32 v9, 0
K1_g0:
    global_load_dword v10, v9, s[66:67] offset:128 sc1
    s_waitcnt vmcnt(0)
    v_cmp_eq_u32 vcc, 1, v10
    s_cbranch_vccnz K1_nosn
    s_sub_u32 s24, s24, 1
    s_cbranch_scc0 K1_g0
K1_nosn:
    s_cmp_lt_u32 s65, 4
    s_cbranch_scc0 K1_gvb
    s_waitcnt vmcnt(8)
    v_lshlrev_b32 v16, 16, v12
    v_mul_f32 v24, 0xbfb8aa3b, v16
    v_and_b32 v17, 0xffff0000, v12
    v_mul_f32 v25, 0xbfb8aa3b, v17
    v_lshlrev_b32 v18, 16, v13
    v_mul_f32 v26, 0xbfb8aa3b, v18
    v_and_b32 v19, 0xffff0000, v13
    v_mul_f32 v27, 0xbfb8aa3b, v19
    v_lshlrev_b32 v20, 16, v14
    v_mul_f32 v28, 0xbfb8aa3b, v20
    v_and_b32 v21, 0xffff0000, v14
    v_mul_f32 v29, 0xbfb8aa3b, v21
    v_lshlrev_b32 v22, 16, v15
    v_mul_f32 v30, 0xbfb8aa3b, v22
    v_and_b32 v23, 0xffff0000, v15
    v_mul_f32 v31, 0xbfb8aa3b, v23
    v_exp_f32 v24, v24
    v_exp_f32 v25, v25
    v_exp_f32 v26, v26
    v_exp_f32 v27, v27
    v_exp_f32 v28, v28
    v_exp_f32 v29, v29
    v_exp_f32 v30, v30
    v_exp_f32 v31, v31
    v_add_f32 v24, 1.0, v24
    v_add_f32 v25, 1.0, v25
    v_add_f32 v26, 1.0, v26
    v_add_f32 v27, 1.0, v27
    v_add_f32 v28, 1.0, v28
    v_add_f32 v29, 1.0, v29
    v_add_f32 v30, 1.0, v30
    v_add_f32 v31, 1.0, v31
    v_rcp_f32 v24, v24
    v_rcp_f32 v25, v25
    v_rcp_f32 v26, v26
    v_rcp_f32 v27, v27
    v_rcp_f32 v28, v28
    v_rcp_f32 v29, v29
    v_rcp_f32 v30, v30
    v_rcp_f32 v31, v31
    v_mul_f32 v16, v16, v24
    v_mul_f32 v17, v17, v25
    v_mul_f32 v18, v18, v26
    v_mul_f32 v19, v19, v27
    v_mul_f32 v20, v20, v28
    v_mul_f32 v21, v21, v29
    v_mul_f32 v22, v22, v30
    v_mul_f32 v23, v23, v31
    v_cvt_pk_bf16_f32 v16, v16, 0
    v_cvt_pk_bf16_f32 v17, v17, 0
    v_cvt_pk_bf16_f32 v18, v18, 0
    v_cvt_pk_bf16_f32 v19, v19, 0
    v_cvt_pk_bf16_f32 v20, v20, 0
    v_cvt_pk_bf16_f32 v21, v21, 0
    v_cvt_pk_bf16_f32 v22, v22, 0
    v_cvt_pk_bf16_f32 v23, v23, 0
    v_lshlrev_b32 v24, 16, v16
    v_lshlrev_b32 v25, 16, v17
    v_lshlrev_b32 v26, 16, v18
    v_lshlrev_b32 v27, 16, v19
    v_lshlrev_b32 v28, 16, v20
    v_lshlrev_b32 v29, 16, v21
    v_lshlrev_b32 v30, 16, v22
    v_lshlrev_b32 v31, 16, v23
    s_waitcnt vmcnt(7)
    v_dot2c_f32_bf16 v64, v16, v32
    v_dot2c_f32_bf16 v65, v24, v32
    v_dot2c_f32_bf16 v66, v16, v33
    v_dot2c_f32_bf16 v67, v24, v33
    v_dot2c_f32_bf16 v68, v16, v34
    v_dot2c_f32_bf16 v69, v24, v34
    v_dot2c_f32_bf16 v70, v16, v35
    v_dot2c_f32_bf16 v71, v24, v35
    s_waitcnt vmcnt(6)
    v_dot2c_f32_bf16 v64, v17, v36
    v_dot2c_f32_bf16 v65, v25, v36
    v_dot2c_f32_bf16 v66, v17, v37
    v_dot2c_f32_bf16 v67, v25, v37
    v_dot2c_f32_bf16 v68, v17, v38
    v_dot2c_f32_bf16 v69, v25, v38
    v_dot2c_f32_bf16 v70, v17, v39
    v_dot2c_f32_bf16 v71, v25, v39
    s_waitcnt vmcnt(5)
    v_dot2c_f32_bf16 v64, v18, v40
    v_dot2c_f32_bf16 v65, v26, v40
    v_dot2c_f32_bf16 v66, v18, v41
    v_dot2c_f32_bf16 v67, v26, v41
    v_dot2c_f32_bf16 v68, v18, v42
    v_dot2c_f32_bf16 v69, v26, v42
    v_dot2c_f32_bf16 v70, v18, v43
    v_dot2c_f32_bf16 v71, v26, v43
    s_waitcnt vmcnt(4)
    v_dot2c_f32_bf16 v64, v19, v44
    v_dot2c_f32_bf16 v65, v27, v44
    v_dot2c_f32_bf16 v66, v19, v45
    v_dot2c_f32_bf16 v67, v27, v45
    v_dot2c_f32_bf16 v68, v19, v46
    v_dot2c_f32_bf16 v69, v27, v46
    v_dot2c_f32_bf16 v70, v19, v47
    v_dot2c_f32_bf16 v71, v27, v47
    s_waitcnt vmcnt(3)
    v_dot2c_f32_bf16 v64, v20, v48
    v_dot2c_f32_bf16 v65, v28, v48
    v_dot2c_f32_bf16 v66, v20, v49
    v_dot2c_f32_bf16 v67, v28, v49
    v_dot2c_f32_bf16 v68, v20, v50
    v_dot2c_f32_bf16 v69, v28, v50
    v_dot2c_f32_bf16 v70, v20, v51
    v_dot2c_f32_bf16 v71, v28, v51
    s_waitcnt vmcnt(2)
    v_dot2c_f32_bf16 v64, v21, v52
    v_dot2c_f32_bf16 v65, v29, v52
    v_dot2c_f32_bf16 v66, v21, v53
    v_dot2c_f32_bf16 v67, v29, v53
    v_dot2c_f32_bf16 v68, v21, v54
    v_dot2c_f32_bf16 v69, v29, v54
    v_dot2c_f32_bf16 v70, v21, v55
    v_dot2c_f32_bf16 v71, v29, v55
    s_waitcnt vmcnt(1)
    v_dot2c_f32_bf16 v64, v22, v56
    v_dot2c_f32_bf16 v65, v30, v56
    v_dot2c_f32_bf16 v66, v22, v57
    v_dot2c_f32_bf16 v67, v30, v57
    v_dot2c_f32_bf16 v68, v22, v58
    v_dot2c_f32_bf16 v69, v30, v58
    v_dot2c_f32_bf16 v70, v22, v59
    v_dot2c_f32_bf16 v71, v30, v59
    s_waitcnt vmcnt(0)
    v_dot2c_f32_bf16 v64, v23, v60
    v_dot2c_f32_bf16 v65, v31, v60
    v_dot2c_f32_bf16 v66, v23, v61
    v_dot2c_f32_bf16 v67, v31, v61
    v_dot2c_f32_bf16 v68, v23, v62
    v_dot2c_f32_bf16 v69, v31, v62
    v_dot2c_f32_bf16 v70, v23, v63
    v_dot2c_f32_bf16 v71, v31, v63
    v_add_f32_dpp v64, v64, v64 row_ror:4 row_mask:0xf bank_mask:0xf
    v_add_f32_dpp v65, v65, v65 row_ror:4 row_mask:0xf bank_mask:0xf
    v_add_f32_dpp v66, v66, v66 row_ror:4 row_mask:0xf bank_mask:0xf
    v_add_f32_dpp v67, v67, v67 row_ror:4 row_mask:0xf bank_mask:0xf
    v_add_f32_dpp v68, v68, v68 row_ror:4 row_mask:0xf bank_mask:0xf
    v_add_f32_dpp v69, v69, v69 row_ror:4 row_mask:0xf bank_mask:0xf
    v_add_f32_dpp v70, v70, v70 row_ror:4 row_mask:0xf bank_mask:0xf
    v_add_f32_dpp v71, v71, v71 row_ror:4 row_mask:0xf bank_mask:0xf
    v_add_f32_dpp v64, v64, v64 row_ror:8 row_mask:0xf bank_mask:0xf
    v_add_f32_dpp v65, v65, v65 row_ror:8 row_mask:0xf bank_mask:0xf
    v_add_f32_dpp v66, v66, v66 row_ror:8 row_mask:0xf bank_mask:0xf
    v_add_f32_dpp v67, v67, v67 row_ror:8 row_mask:0xf bank_mask:0xf
    v_add_f32_dpp v68, v68, v68 row_ror:8 row_mask:0xf bank_mask:0xf
    v_add_f32_dpp v69, v69, v69 row_ror:8 row_mask:0xf bank_mask:0xf
    v_add_f32_dpp v70, v70, v70 row_ror:8 row_mask:0xf bank_mask:0xf
    v_add_f32_dpp v71, v71, v71 row_ror:8 row_mask:0xf bank_mask:0xf
    s_mov_b32 exec_lo, 0x000f000f
    s_mov_b32 exec_hi, 0x000f000f
    ds_write_b128 v5, v[64:67]
    ds_write_b128 v5, v[68:71] offset:16
    s_mov_b64 exec, -1
    s_waitcnt lgkmcnt(0)
K1_gvb:
    s_barrier
    v_cmp_gt_u32 vcc, 64, v0
    s_nop 0
    s_and_saveexec_b64 s[30:31], vcc
    s_cbranch_execz K1_gv2
    ds_read_b32 v16, v8 offset:0
    ds_read_b32 v17, v8 offset:128
    ds_read_b32 v18, v8 offset:256
    ds_read_b32 v19, v8 offset:384
    ds_read_b32 v20, v8 offset:512
    ds_read_b32 v21, v8 offset:640
    ds_read_b32 v22, v8 offset:768
    ds_read_b32 v23, v8 offset:896
    s_lshr_b32 s28, s3, 4
    s_and_b32 s29, s3, 15
    s_lshl_b32 s29, s29, 5
    v_add_u32 v10, s29, v7
    v_sub_u32 v11, 0x200, v10
    v_and_b32 v11, 0xff, v11
    v_cmp_gt_u32 vcc, 0x100, v10
    s_nop 1
    v_cndmask_b32 v12, v11, v10, vcc
    v_cndmask_b32 v13, 32, 0, vcc
    v_lshrrev_b32 v14, 5, v12
    v_and_b32 v12, 31, v12
    v_lshl_add_u32 v12, v14, 6, v12
    v_add_u32 v12, v12, v13
    s_sub_u32 s32, s28, 2
    s_cmp_lt_u32 s32, 3
    s_cselect_b64 vcc, -1, 0
    v_cndmask_b32 v10, v10, v12, vcc
    v_lshlrev_b32 v10, 2, v10
    s_lshl_b32 s33, s28, 11
    s_add_u32 s33, s33, 2097152
    s_cmp_eq_u32 s28, 1
    s_cselect_b32 s34, 1.0, 0
    s_cselect_b32 s35, 0x3b800000, 1.0
    s_cmp_eq_u32 s28, 4
    s_cselect_b32 s34, 1.0, s34
    s_cmp_eq_u32 s28, 2
    s_cselect_b32 s35, 0x43800000, s35
    s_waitcnt lgkmcnt(0)
    v_add_f32 v16, v16, v20
    v_add_f32 v17, v17, v21
    v_add_f32 v18, v18, v22
    v_add_f32 v19, v19, v23
    v_add_f32 v16, v16, v18
    v_add_f32 v17, v17, v19
    v_add_f32 v16, v16, v17
    v_mov_b32 v17, v16
    s_nop 1
    v_permlane32_swap_b32 v16, v17
    v_add_f32 v16, v16, v17
    v_cvt_pk_bf16_f32 v16, v16, 0
    v_lshlrev_b32 v16, 16, v16
    v_add_f32 v16, s34, v16
    v_cvt_pk_bf16_f32 v16, v16, 0
    v_lshlrev_b32 v16, 16, v16
    v_mul_f32 v16, s35, v16
    v_min_u32 v16, -2, v16
    s_mov_b32 exec_hi, 0
    buffer_store_dword v16, v10, s[12:15], s33 offen sc1
    ds_write_b32 v8, v16 offset:4096
    s_waitcnt lgkmcnt(0)
K1_gv2:
    s_mov_b64 exec, -1
    s_cmp_lt_u32 s3, 16
    s_cbranch_scc0 K1_gv3
    s_barrier
    v_mov_b32 v9, 0
    ds_read_b128 v[16:19], v9 offset:4096
    ds_read_b128 v[20:23], v9 offset:4112
    ds_read_b128 v[24:27], v9 offset:4128
    ds_read_b128 v[28:31], v9 offset:4144
    ds_read_b128 v[32:35], v9 offset:4160
    ds_read_b128 v[36:39], v9 offset:4176
    ds_read_b128 v[40:43], v9 offset:4192
    ds_read_b128 v[44:47], v9 offset:4208
    v_lshlrev_b32 v10, 2, v0
    s_lshl_b32 s24, s3, 11
    s_add_u32 s24, s24, 2113536
    s_waitcnt lgkmcnt(0)
    v_mul_f32 v12, v16, v80
    v_mul_f32 v13, v17, v81
    v_fmac_f32 v12, v18, v82
    v_fmac_f32 v13, v19, v83
    v_fmac_f32 v12, v20, v84
    v_fmac_f32 v13, v21, v85
    v_fmac_f32 v12, v22, v86
    v_fmac_f32 v13, v23, v87
    v_fmac_f32 v12, v24, v88
    v_fmac_f32 v13, v25, v89
    v_fmac_f32 v12, v26, v90
    v_fmac_f32 v13, v27, v91
    v_fmac_f32 v12, v28, v92
    v_fmac_f32 v13, v29, v93
    v_fmac_f32 v12, v30, v94
    v_fmac_f32 v13, v31, v95
    v_fmac_f32 v12, v32, v96
    v_fmac_f32 v13, v33, v97
    v_fmac_f32 v12, v34, v98
    v_fmac_f32 v13, v35, v99
    v_fmac_f32 v12, v36, v100
    v_fmac_f32 v13, v37, v101
    v_fmac_f32 v12, v38, v102
    v_fmac_f32 v13, v39, v103
    v_fmac_f32 v12, v40, v104
    v_fmac_f32 v13, v41, v105
    v_fmac_f32 v12, v42, v106
    v_fmac_f32 v13, v43, v107
    v_fmac_f32 v12, v44, v108
    v_fmac_f32 v13, v45, v109
    v_fmac_f32 v12, v46, v110
    v_fmac_f32 v13, v47, v111
    v_add_f32 v12, v12, v13
    buffer_store_dword v12, v10, s[12:15], s24 offen sc1
    s_branch K1_done
K1_gv3:
    s_branch K1_done
K1_rel:
    s_sub_u32 s36, s2, 160
    s_waitcnt lgkmcnt(0)
    s_cmp_eq_u32 s65, 0
    s_cbranch_scc0 K1_rjob
    s_cmp_lt_u32 s36, 73
    s_cbranch_scc0 K1_rpre
    s_mov_b32 s52, s4
    s_mov_b32 s53, s5
    s_mov_b32 s54, 0x300000
    s_mov_b32 s55, 0x20000
    v_and_b32 v1, 63, v0
    v_lshlrev_b32 v1, 4, v1
    s_lshl_b32 s21, s36, 13
    s_add_u32 s22, s21, 2621440
    s_add_u32 s23, s21, 1638400
    s_cmp_lt_u32 s36, 64
    s_cselect_b32 s22, s22, s23
    s_cselect_b32 s24, -1, 0
    s_add_u32 s23, s22, 4096
    v_mov_b32 v8, s24
    v_mov_b32 v9, s24
    v_mov_b32 v10, s24
    v_mov_b32 v11, s24
    buffer_store_dwordx4 v[8:11], v1, s[52:55], s22 offen offset:0 sc1
    buffer_store_dwordx4 v[8:11], v1, s[52:55], s22 offen offset:1024 sc1
    buffer_store_dwordx4 v[8:11], v1, s[52:55], s22 offen offset:2048 sc1
    buffer_store_dwordx4 v[8:11], v1, s[52:55], s22 offen offset:3072 sc1
    buffer_store_dwordx4 v[8:11], v1, s[52:55], s23 offen offset:0 sc1
    buffer_store_dwordx4 v[8:11], v1, s[52:55], s23 offen offset:1024 sc1
    buffer_store_dwordx4 v[8:11], v1, s[52:55], s23 offen offset:2048 sc1
    buffer_store_dwordx4 v[8:11], v1, s[52:55], s23 offen offset:3072 sc1
    s_cmp_eq_u32 s36, 72
    s_cbranch_scc0 K1_rpre
    v_mov_b32 v12, -1
    v_mov_b32 v13, -1
    v_mov_b32 v14, -1
    v_mov_b32 v15, -1
    s_mov_b32 s22, 2099200
    buffer_store_dwordx4 v[12:15], v1, s[52:55], s22 offen offset:0 sc1
    buffer_store_dwordx4 v[12:15], v1, s[52:55], s22 offen offset:1024 sc1
    s_waitcnt vmcnt(0)
    s_mov_b32 s64, 1
    s_mov_b32 s58, s64
    s_atomic_add s58, s[66:67], 0 glc
    s_mov_b32 s52, s4
    s_mov_b32 s53, s5
    s_mov_b32 s54, 0x300000
    s_mov_b32 s55, 0x20000
    v_and_b32 v120, 15, v0
    v_lshlrev_b32 v120, 7, v120
    v_mov_b32 v121, 1
    s_mov_b32 s57, 2232320
    s_waitcnt lgkmcnt(0)
    s_add_u32 s58, s58, s64
    s_and_b32 s59, s58, 0xff
    s_cmp_eq_u32 s59, 1
    s_cbranch_scc0 K1_nap
    s_cmp_eq_u32 s64, 1
    s_cbranch_scc0 K1_nbp
    s_mov_b32 s59, 1
    s_atomic_add s59, s[66:67], 128
K1_nbp:
    s_lshr_b32 s59, s58, 16
    s_cmp_eq_u32 s59, 64
    s_cbranch_scc0 K1_nap
    s_mov_b64 exec, 0xffff
    buffer_store_dword v121, v120, s[52:55], s57 offen offset:4 sc1
    s_mov_b64 exec, -1
K1_nap:
K1_rpre:
    s_call_b64 s[62:63], KC_pre
    s_branch K1_done
K1_rjob:
    v_and_b32 v2, 63, v0
    v_and_b32 v3, 31, v2
    v_lshrrev_b32 v4, 5, v2
    v_lshlrev_b32 v5, 4, v2
    s_mul_i32 s37, s65, 96
    s_add_u32 s37, s37, s2
    s_sub_u32 s37, s37, 256
SJ_go:
    s_load_dwordx4 s[16:19], s[0:1], 48
    s_load_dwordx2 s[14:15], s[0:1], 64
    s_cmp_ge_u32 s37, 448
    s_cbranch_scc1 SJ_d
    v_mov_b32 v16, v5
    s_lshr_b32 s44, s37, 5
    s_and_b32 s45, s37, 31
    s_lshr_b32 s46, s45, 2
    s_lshl_b32 s46, s46, 5
    s_and_b32 s47, s45, 1
    s_lshl_b32 s47, s47, 4
    s_add_u32 s46, s46, s47
    v_lshl_add_u32 v17, v4, 3, s46
    s_bitcmp1_b32 s45, 1
    s_cbranch_scc1 SJ_mir
    s_mov_b32 s28, 0
    s_mov_b32 s29, 3584
    s_mov_b32 s30, 7168
    s_mov_b32 s31, 10752
    s_mov_b32 s32, 14336
    s_mov_b32 s33, 17920
    s_mov_b32 s34, 21504
    s_mov_b32 s35, 25088
    v_mov_b32 v18, v17
    s_branch SJ_gu2
SJ_mir:
    s_mov_b32 s28, 25088
    s_mov_b32 s29, 21504
    s_mov_b32 s30, 17920
    s_mov_b32 s31, 14336
    s_mov_b32 s32, 10752
    s_mov_b32 s33, 7168
    s_mov_b32 s34, 3584
    s_mov_b32 s35, 0
    v_sub_u32 v17, 505, v17
    v_cmp_eq_u32 vcc, 505, v17
    v_mov_b32 v18, 249
    s_nop 0
    v_cndmask_b32 v18, v17, v18, vcc
SJ_gu2:
    v_mul_u32_u24 v17, 3584, v17
    v_mul_u32_u24 v18, 3584, v18
    s_lshl_b32 s46, s44, 8
    v_and_b32 v19, 15, v3
    v_lshl_add_u32 v19, v19, 4, s46
    v_add_u32 v17, v17, v19
    v_add_u32 v18, v18, v19
    s_and_b32 s46, s44, 1
    s_mul_i32 s46, s46, 229376
    s_lshr_b32 s47, s44, 1
    s_lshl_b32 s47, s47, 15
    s_add_u32 s46, s46, s47
    s_lshl_b32 s47, s45, 10
    s_add_u32 s20, s46, s47
    s_add_u32 s21, s20, 458752
    s_add_u32 s22, s21, 458752
    s_add_u32 s23, s22, 458752
    s_add_u32 s24, s23, 458752
    s_add_u32 s25, s24, 458752
    s_add_u32 s26, s25, 458752
    s_add_u32 s27, s26, 458752
    s_waitcnt lgkmcnt(0)
    v_cmp_gt_u32 vcc, 16, v3
    v_mov_b32 v20, s18
    v_mov_b32 v21, s16
    v_cndmask_b32 v20, v20, v21, vcc
    v_mov_b32 v21, s19
    v_mov_b32 v22, s17
    v_cndmask_b32 v21, v21, v22, vcc
    s_branch SJ_ld
SJ_d:
    s_sub_u32 s37, s37, 448
    s_and_b32 s44, s37, 7
    s_lshr_b32 s45, s37, 4
    s_bfe_u32 s46, s37, 0x10003
    s_lshl_b32 s47, s45, 7
    s_add_u32 s47, s47, s44
    v_lshl_add_u32 v17, v4, 5, s47
    v_lshlrev_b32 v17, 10, v17
    s_lshl_b32 s47, s46, 9
    v_lshl_add_u32 v19, v3, 4, s47
    v_add_u32 v17, v17, v19
    v_mov_b32 v18, v17
    v_lshrrev_b32 v16, 3, v3
    v_mul_u32_u24 v16, 28672, v16
    v_lshl_add_u32 v16, v4, 9, v16
    v_and_b32 v19, 7, v3
    v_lshl_add_u32 v16, v19, 4, v16
    s_mov_b32 s28, 0
    s_mov_b32 s29, 8192
    s_mov_b32 s30, 16384
    s_mov_b32 s31, 24576
    s_mov_b32 s32, 65536
    s_mov_b32 s33, 73728
    s_mov_b32 s34, 81920
    s_mov_b32 s35, 90112
    s_mul_i32 s44, s44, 229376
    s_mul_i32 s46, s46, 114688
    s_add_u32 s44, s44, s46
    s_lshl_b32 s45, s45, 11
    s_add_u32 s44, s44, s45
    s_add_u32 s20, s44, 3670016
    s_add_u32 s21, s44, 3670144
    s_add_u32 s22, s44, 3670272
    s_add_u32 s23, s44, 3670400
    s_add_u32 s24, s44, 3671040
    s_add_u32 s25, s44, 3671168
    s_add_u32 s26, s44, 3671296
    s_add_u32 s27, s44, 3671424
    s_waitcnt lgkmcnt(0)
    v_mov_b32 v20, s14
    v_mov_b32 v21, s15
SJ_ld:
    v_add_u32 v19, s28, v18
    v_add_co_u32 v96, vcc, v20, v19
    s_nop 1
    v_addc_co_u32 v97, vcc, 0, v21, vcc
    global_load_dwordx4 v[32:35], v[96:97], off nt
    v_add_u32 v19, s29, v17
    v_add_co_u32 v98, vcc, v20, v19
    s_nop 1
    v_addc_co_u32 v99, vcc, 0, v21, vcc
    global_load_dwordx4 v[36:39], v[98:99], off nt
    v_add_u32 v19, s30, v17
    v_add_co_u32 v100, vcc, v20, v19
    s_nop 1
    v_addc_co_u32 v101, vcc, 0, v21, vcc
    global_load_dwordx4 v[40:43], v[100:101], off nt
    v_add_u32 v19, s31, v17
    v_add_co_u32 v102, vcc, v20, v19
    s_nop 1
    v_addc_co_u32 v103, vcc, 0, v21, vcc
    global_load_dwordx4 v[44:47], v[102:103], off nt
    v_add_u32 v19, s32, v17
    v_add_co_u32 v104, vcc, v20, v19
    s_nop 1
    v_addc_co_u32 v105, vcc, 0, v21, vcc
    global_load_dwordx4 v[48:51], v[104:105], off nt
    v_add_u32 v19, s33, v17
    v_add_co_u32 v106, vcc, v20, v19
    s_nop 1
    v_addc_co_u32 v107, vcc, 0, v21, vcc
    global_load_dwordx4 v[52:55], v[106:107], off nt
    v_add_u32 v19, s34, v17
    v_add_co_u32 v108, vcc, v20, v19
    s_nop 1
    v_addc_co_u32 v109, vcc, 0, v21, vcc
    global_load_dwordx4 v[56:59], v[108:109], off nt
    v_add_u32 v19, s35, v17
    v_add_co_u32 v110, vcc, v20, v19
    s_nop 1
    v_addc_co_u32 v111, vcc, 0, v21, vcc
    global_load_dwordx4 v[60:63], v[110:111], off nt
    s_call_b64 s[62:63], KC_pre
    s_add_u32 s12, s4, 0x400000
    s_addc_u32 s13, s5, 0
    s_mov_b32 s14, 0x540000
    s_mov_b32 s15, 0x20000
    s_mov_b32 s48, 0x05040100
    s_mov_b32 s49, 0x07060302
    s_waitcnt vmcnt(6)
    v_perm_b32 v64, v36, v32, s48
    v_perm_b32 v68, v36, v32, s49
    v_perm_b32 v72, v37, v33, s48
    v_perm_b32 v76, v37, v33, s49
    v_perm_b32 v80, v38, v34, s48
    v_perm_b32 v84, v38, v34, s49
    v_perm_b32 v88, v39, v35, s48
    v_perm_b32 v92, v39, v35, s49
    s_waitcnt vmcnt(4)
    v_perm_b32 v65, v44, v40, s48
    v_perm_b32 v69, v44, v40, s49
    v_perm_b32 v73, v45, v41, s48
    v_perm_b32 v77, v45, v41, s49
    v_perm_b32 v81, v46, v42, s48
    v_perm_b32 v85, v46, v42, s49
    v_perm_b32 v89, v47, v43, s48
    v_perm_b32 v93, v47, v43, s49
    s_waitcnt vmcnt(2)
    v_perm_b32 v66, v52, v48, s48
    v_perm_b32 v70, v52, v48, s49
    v_perm_b32 v74, v53, v49, s48
    v_perm_b32 v78, v53, v49, s49
    v_perm_b32 v82, v54, v50, s48
    v_perm_b32 v86, v54, v50, s49
    v_perm_b32 v90, v55, v51, s48
    v_perm_b32 v94, v55, v51, s49
    s_waitcnt vmcnt(0)
    v_perm_b32 v67, v60, v56, s48
    v_perm_b32 v71, v60, v56, s49
    v_perm_b32 v75, v61, v57, s48
    v_perm_b32 v79, v61, v57, s49
    v_perm_b32 v83, v62, v58, s48
    v_perm_b32 v87, v62, v58, s49
    v_perm_b32 v91, v63, v59, s48
    v_perm_b32 v95, v63, v59, s49
    buffer_store_dwordx4 v[64:67], v16, s[12:15], s20 offen sc1
    buffer_store_dwordx4 v[68:71], v16, s[12:15], s21 offen sc1
    buffer_store_dwordx4 v[72:75], v16, s[12:15], s22 offen sc1
    buffer_store_dwordx4 v[76:79], v16, s[12:15], s23 offen sc1
    buffer_store_dwordx4 v[80:83], v16, s[12:15], s24 offen sc1
    buffer_store_dwordx4 v[84:87], v16, s[12:15], s25 offen sc1
    buffer_store_dwordx4 v[88:91], v16, s[12:15], s26 offen sc1
    buffer_store_dwordx4 v[92:95], v16, s[12:15], s27 offen sc1
SJ_end:
    s_branch K1_done
K1_arrive:
    s_waitcnt vmcnt(0)
    s_barrier
K1_arr2:
    s_cmp_eq_u32 s65, 0
    s_cbranch_scc0 K1_done
K1_arr3:
    s_mov_b32 s58, s64
    s_atomic_add s58, s[66:67], 0 glc
    s_mov_b32 s52, s4
    s_mov_b32 s53, s5
    s_mov_b32 s54, 0x300000
    s_mov_b32 s55, 0x20000
    v_and_b32 v120, 15, v0
    v_lshlrev_b32 v120, 7, v120
    v_mov_b32 v121, 1
    s_mov_b32 s57, 2232320
    s_waitcnt lgkmcnt(0)
    s_add_u32 s58, s58, s64
    s_and_b32 s59, s58, 0xff
    s_cmp_eq_u32 s59, 1
    s_cbranch_scc0 K1_naz
    s_cmp_eq_u32 s64, 1
    s_cbranch_scc0 K1_nbz
    s_mov_b32 s59, 1
    s_atomic_add s59, s[66:67], 128
K1_nbz:
    s_lshr_b32 s59, s58, 16
    s_cmp_eq_u32 s59, 64
    s_cbranch_scc0 K1_naz
    s_mov_b64 exec, 0xffff
    buffer_store_dword v121, v120, s[52:55], s57 offen offset:4 sc1
    s_mov_b64 exec, -1
K1_naz:
K1_done:
    s_mov_b64 exec, -1
    s_mov_b64 s[50:51], s[66:67]
    s_load_dwordx2 s[4:5], s[0:1], 104
    s_load_dwordx2 s[6:7], s[0:1], 0
    s_load_dwordx2 s[68:69], s[0:1], 88
    v_lshrrev_b32 v1, 6, v0
    s_nop 0
    v_readfirstlane_b32 s3, v1
    s_bfe_u32 s20, s2, 0x30003
    s_and_b32 s21, s2, 7
    s_lshl_b32 s21, s21, 2
    s_lshr_b32 s22, s2, 6
    s_add_u32 s21, s21, s22
    v_and_b32 v2, 63, v0
    v_and_b32 v3, 31, v2
    v_lshrrev_b32 v4, 5, v2
    v_lshlrev_b32 v5, 4, v2
    v_lshlrev_b32 v6, 5, v2
    s_add_u32 s70, s3, s20
    s_and_b32 s70, s70, 7
    s_lshl_b32 s25, s3, 13
    s_lshl_b32 s26, s70, 13
    s_lshl_b32 s24, s21, 16
    s_add_u32 s24, s24, s26
    s_mov_b32 s27, 2099200
    s_mov_b32 m0, s26
    s_and_b32 s36, s3, 1
    s_bfe_u32 s37, s3, 0x10001
    s_cmp_lt_u32 s3, 4
    s_cbranch_scc1 KC_noxl
    s_waitcnt lgkmcnt(0)
    v_lshlrev_b32 v7, 6, v3
    v_add_u32 v7, s21, v7
    s_cmp_eq_u32 s36, 0
    s_cbranch_scc1 KC_tok_done
    v_add_u32 v8, 32, v7
    v_sub_u32 v7, 0x800, v7
    s_cmp_eq_u32 s21, 0
    s_cselect_b64 vcc, -1, 0
    v_cndmask_b32 v7, v7, v8, vcc
KC_tok_done:
    s_mov_b32 s40, s6
    s_mov_b32 s41, s7
    s_mov_b32 s42, 0x200000
    s_mov_b32 s43, 0x20000
    v_lshlrev_b32 v8, 10, v7
    s_lshl_b32 s38, s20, 6
    v_lshl_add_u32 v9, v4, 4, s38
    v_sub_u32 v10, 1008, v9
    s_cmp_eq_u32 s37, 0
    s_cselect_b64 vcc, -1, 0
    s_cselect_b32 s44, 32, -32
    v_cndmask_b32 v10, v10, v9, vcc
    v_add_u32 v10, v8, v10
    v_add_u32 v11, s44, v10
    buffer_load_dwordx4 v[120:123], v10, s[40:43], 0 offen
    buffer_load_dwordx4 v[124:127], v11, s[40:43], 0 offen
    buffer_load_ushort v15, v11, s[40:43], 0 offen offset:16
    v_sub_u32 v11, 0x400, v9
    v_cmp_eq_u32 vcc, 0, v9
    v_mov_b32 v12, 0x200
    s_lshl_b32 s39, s20, 8
    v_cndmask_b32 v11, v11, v12, vcc
    v_add_u32 v11, v8, v11
    buffer_load_ushort v14, v11, s[40:43], 0 offen
KC_noxl:
    s_waitcnt lgkmcnt(0)
    s_cmp_lt_u32 s3, 4
    s_cbranch_scc1 KC_mgd
    v_cvt_f32_u32 v9, v7
    v_mul_f32 v9, 0x3a000000, v9
    v_lshlrev_b32 v10, 2, v4
    v_cvt_f32_u32 v10, v10
    v_mul_f32 v10, v9, v10
    v_fmamk_f32 v208, v9, 0x00000000, v10
    v_fmamk_f32 v209, v9, 0x3f800000, v10
    v_fmamk_f32 v210, v9, 0x40000000, v10
    v_fmamk_f32 v211, v9, 0x40400000, v10
    v_fmamk_f32 v212, v9, 0x41000000, v10
    v_fmamk_f32 v213, v9, 0x41100000, v10
    v_fmamk_f32 v214, v9, 0x41200000, v10
    v_fmamk_f32 v215, v9, 0x41300000, v10
    v_fmamk_f32 v216, v9, 0x41800000, v10
    v_fmamk_f32 v217, v9, 0x41880000, v10
    v_fmamk_f32 v218, v9, 0x41900000, v10
    v_fmamk_f32 v219, v9, 0x41980000, v10
    v_fmamk_f32 v220, v9, 0x41c00000, v10
    v_fmamk_f32 v221, v9, 0x41c80000, v10
    v_fmamk_f32 v222, v9, 0x41d00000, v10
    v_fmamk_f32 v223, v9, 0x41d80000, v10
    v_cos_f32 v192, v208
    v_sin_f32 v208, v208
    v_cos_f32 v193, v209
    v_sin_f32 v209, v209
    v_cos_f32 v194, v210
    v_sin_f32 v210, v210
    v_cos_f32 v195, v211
    v_sin_f32 v211, v211
    v_cos_f32 v196, v212
    v_sin_f32 v212, v212
    v_cos_f32 v197, v213
    v_sin_f32 v213, v213
    v_cos_f32 v198, v214
    v_sin_f32 v214, v214
    v_cos_f32 v199, v215
    v_sin_f32 v215, v215
    v_cos_f32 v200, v216
    v_sin_f32 v216, v216
    v_cos_f32 v201, v217
    v_sin_f32 v217, v217
    v_cos_f32 v202, v218
    v_sin_f32 v218, v218
    v_cos_f32 v203, v219
    v_sin_f32 v219, v219
    v_cos_f32 v204, v220
    v_sin_f32 v220, v220
    v_cos_f32 v205, v221
    v_sin_f32 v221, v221
    v_cos_f32 v206, v222
    v_sin_f32 v222, v222
    v_cos_f32 v207, v223
    v_sin_f32 v223, v223
    v_cvt_pk_f16_f32 v224, v192, v193
    v_cvt_pk_f16_f32 v240, v208, v209
    v_cvt_pk_f16_f32 v225, v194, v195
    v_cvt_pk_f16_f32 v241, v210, v211
    v_cvt_pk_f16_f32 v226, v196, v197
    v_cvt_pk_f16_f32 v242, v212, v213
    v_cvt_pk_f16_f32 v227, v198, v199
    v_cvt_pk_f16_f32 v243, v214, v215
    v_cvt_pk_f16_f32 v228, v200, v201
    v_cvt_pk_f16_f32 v244, v216, v217
    v_cvt_pk_f16_f32 v229, v202, v203
    v_cvt_pk_f16_f32 v245, v218, v219
    v_cvt_pk_f16_f32 v230, v204, v205
    v_cvt_pk_f16_f32 v246, v220, v221
    v_cvt_pk_f16_f32 v231, v206, v207
    v_cvt_pk_f16_f32 v247, v222, v223
    s_mov_b32 s52, 0x80008000
    s_cmp_eq_u32 s36, 0
    s_cselect_b32 s53, 0, s52
    s_cselect_b32 s56, -1, 0
    s_cselect_b32 s57, 0, -1
    s_cmp_eq_u32 s37, 0
    s_cselect_b32 s54, 0, s52
    s_xor_b32 s55, s53, s54
    s_xor_b32 s55, s55, s52
    s_cmp_eq_u32 s21, 0
    s_cbranch_scc1 KC_mspec
    v_xor_b32 v232, s53, v240
    v_xor_b32 v248, s55, v224
    v_xor_b32 v240, s54, v240
    v_xor_b32 v233, s53, v241
    v_xor_b32 v249, s55, v225
    v_xor_b32 v241, s54, v241
    v_xor_b32 v234, s53, v242
    v_xor_b32 v250, s55, v226
    v_xor_b32 v242, s54, v242
    v_xor_b32 v235, s53, v243
    v_xor_b32 v251, s55, v227
    v_xor_b32 v243, s54, v243
    v_xor_b32 v236, s53, v244
    v_xor_b32 v252, s55, v228
    v_xor_b32 v244, s54, v244
    v_xor_b32 v237, s53, v245
    v_xor_b32 v253, s55, v229
    v_xor_b32 v245, s54, v245
    v_xor_b32 v238, s53, v246
    v_xor_b32 v254, s55, v230
    v_xor_b32 v246, s54, v246
    v_xor_b32 v239, s53, v247
    v_xor_b32 v255, s55, v231
    v_xor_b32 v247, s54, v247
    s_branch KC_mgd
KC_mspec:
    v_xor_b32 v240, s54, v240
    v_and_b32 v232, s57, v224
    v_and_b32 v224, s56, v224
    v_and_b32 v248, s57, v240
    v_and_b32 v240, s56, v240
    v_xor_b32 v241, s54, v241
    v_and_b32 v233, s57, v225
    v_and_b32 v225, s56, v225
    v_and_b32 v249, s57, v241
    v_and_b32 v241, s56, v241
    v_xor_b32 v242, s54, v242
    v_and_b32 v234, s57, v226
    v_and_b32 v226, s56, v226
    v_and_b32 v250, s57, v242
    v_and_b32 v242, s56, v242
    v_xor_b32 v243, s54, v243
    v_and_b32 v235, s57, v227
    v_and_b32 v227, s56, v227
    v_and_b32 v251, s57, v243
    v_and_b32 v243, s56, v243
    v_xor_b32 v244, s54, v244
    v_and_b32 v236, s57, v228
    v_and_b32 v228, s56, v228
    v_and_b32 v252, s57, v244
    v_and_b32 v244, s56, v244
    v_xor_b32 v245, s54, v245
    v_and_b32 v237, s57, v229
    v_and_b32 v229, s56, v229
    v_and_b32 v253, s57, v245
    v_and_b32 v245, s56, v245
    v_xor_b32 v246, s54, v246
    v_and_b32 v238, s57, v230
    v_and_b32 v230, s56, v230
    v_and_b32 v254, s57, v246
    v_and_b32 v246, s56, v246
    v_xor_b32 v247, s54, v247
    v_and_b32 v239, s57, v231
    v_and_b32 v231, s56, v231
    v_and_b32 v255, s57, v247
    v_and_b32 v247, s56, v247
KC_mgd:
    s_mov_b32 s8, s4
    s_mov_b32 s9, s5
    s_mov_b32 s10, 0x300000
    s_mov_b32 s11, 0x20000
    s_cmp_eq_u32 s3, 0
    s_cbranch_scc0 KC_ba
    s_mov_b32 s47, 30000
    v_mov_b32 v12, 0
KC_gw1:
    global_load_dword v13, v12, s[50:51] offset:128 sc1
    s_waitcnt vmcnt(0)
    v_cmp_eq_u32 vcc, 1, v13
    s_cbranch_vccnz KC_gg1
    s_sleep 2
    s_sub_u32 s47, s47, 1
    s_cbranch_scc0 KC_gw1
KC_gg1:
KC_ba:
    s_waitcnt vmcnt(0)
    s_barrier
    buffer_load_dwordx4 v[64:67], v6, s[8:11], s27 offen sc1
    buffer_load_dwordx4 v[68:71], v6, s[8:11], s27 offen offset:16 sc1
    v_mov_b32 v12, 157952
    v_mov_b32 v16, 0
    v_mov_b32 v17, 0
    v_mov_b32 v18, 0
    v_mov_b32 v19, 0
    ds_write_b128 v12, v[16:19]
    ds_write_b128 v12, v[16:19] offset:16
    s_cmp_eq_u32 s3, 0
    s_cbranch_scc0 KC_nodw
    s_cmp_lt_u32 s2, 64
    s_cbranch_scc1 KC_nodw
    s_and_b32 s46, s2, 15
    s_lshl_b32 s46, s46, 7
    s_lshr_b32 s47, s2, 4
    s_lshl_b32 s47, s47, 2
    s_add_u32 s46, s46, s47
    s_add_u32 s46, s46, 2228208
    v_mov_b32 v12, 0
    v_mov_b32 v13, 1
    s_mov_b64 exec, 1
    buffer_store_dword v13, v12, s[8:11], s46 offen sc1
    s_mov_b64 exec, -1
KC_nodw:
    s_mov_b32 s47, 30000
    s_branch KC_cac
KC_cal:
    s_sleep 2
    buffer_load_dwordx4 v[64:67], v6, s[8:11], s27 offen sc1
    buffer_load_dwordx4 v[68:71], v6, s[8:11], s27 offen offset:16 sc1
KC_cac:
    s_waitcnt vmcnt(0)
    v_max3_u32 v12, v64, v65, v66
    v_max3_u32 v13, v67, v68, v69
    v_max3_u32 v12, v12, v70, v71
    v_max_u32 v12, v12, v13
    v_cmp_eq_u32 vcc, -1, v12
    s_cbranch_vccz KC_cad
    s_sub_u32 s47, s47, 1
    s_cbranch_scc0 KC_cal
KC_cad:
    v_pk_mul_f32 v[168:169], v[168:169], v[64:65]
    v_pk_mul_f32 v[170:171], v[170:171], v[66:67]
    v_pk_mul_f32 v[172:173], v[172:173], v[68:69]
    v_pk_mul_f32 v[174:175], v[174:175], v[70:71]
    v_pk_mul_f32 v[144:145], v[144:145], v[64:65]
    v_pk_mul_f32 v[146:147], v[146:147], v[66:67]
    v_pk_mul_f32 v[148:149], v[148:149], v[68:69]
    v_pk_mul_f32 v[150:151], v[150:151], v[70:71]
    v_pk_mul_f32 v[152:153], v[152:153], v[64:65]
    v_pk_mul_f32 v[154:155], v[154:155], v[66:67]
    v_pk_mul_f32 v[156:157], v[156:157], v[68:69]
    v_pk_mul_f32 v[158:159], v[158:159], v[70:71]
    v_cvt_pk_f16_f32 v88, v168, v169
    v_cvt_pk_f16_f32 v89, v170, v171
    v_cvt_pk_f16_f32 v90, v172, v173
    v_cvt_pk_f16_f32 v91, v174, v175
    ds_write_b128 v176, v[88:91] offset:0
    v_cvt_pk_f16_f32 v92, v152, v153
    v_cvt_pk_f16_f32 v93, v154, v155
    v_cvt_pk_f16_f32 v94, v156, v157
    v_cvt_pk_f16_f32 v95, v158, v159
    ds_write_b128 v177, v[92:95] offset:1024
    v_pk_fma_f32 v[160:161], v[136:137], v[152:153], v[144:145] neg_lo:[0,0,1] neg_hi:[0,0,1]
    v_pk_fma_f32 v[162:163], v[138:139], v[154:155], v[146:147] neg_lo:[0,0,1] neg_hi:[0,0,1]
    v_pk_fma_f32 v[164:165], v[140:141], v[156:157], v[148:149] neg_lo:[0,0,1] neg_hi:[0,0,1]
    v_pk_fma_f32 v[166:167], v[142:143], v[158:159], v[150:151] neg_lo:[0,0,1] neg_hi:[0,0,1]
    v_cvt_pk_f16_f32 v96, v160, v161
    v_cvt_pk_f16_f32 v97, v162, v163
    v_cvt_pk_f16_f32 v98, v164, v165
    v_cvt_pk_f16_f32 v99, v166, v167
    ds_write_b128 v178, v[96:99] offset:2048
    v_pk_fma_f32 v[144:145], v[136:137], v[160:161], v[152:153] neg_lo:[0,0,1] neg_hi:[0,0,1]
    v_pk_fma_f32 v[146:147], v[138:139], v[162:163], v[154:155] neg_lo:[0,0,1] neg_hi:[0,0,1]
    v_pk_fma_f32 v[148:149], v[140:141], v[164:165], v[156:157] neg_lo:[0,0,1] neg_hi:[0,0,1]
    v_pk_fma_f32 v[150:151], v[142:143], v[166:167], v[158:159] neg_lo:[0,0,1] neg_hi:[0,0,1]
    v_cvt_pk_f16_f32 v100, v144, v145
    v_cvt_pk_f16_f32 v101, v146, v147
    v_cvt_pk_f16_f32 v102, v148, v149
    v_cvt_pk_f16_f32 v103, v150, v151
    ds_write_b128 v179, v[100:103] offset:3072
    v_pk_fma_f32 v[152:153], v[136:137], v[144:145], v[160:161] neg_lo:[0,0,1] neg_hi:[0,0,1]
    v_pk_fma_f32 v[154:155], v[138:139], v[146:147], v[162:163] neg_lo:[0,0,1] neg_hi:[0,0,1]
    v_pk_fma_f32 v[156:157], v[140:141], v[148:149], v[164:165] neg_lo:[0,0,1] neg_hi:[0,0,1]
    v_pk_fma_f32 v[158:159], v[142:143], v[150:151], v[166:167] neg_lo:[0,0,1] neg_hi:[0,0,1]
    s_waitcnt lgkmcnt(3)
    v_cvt_pk_f16_f32 v88, v152, v153
    v_cvt_pk_f16_f32 v89, v154, v155
    v_cvt_pk_f16_f32 v90, v156, v157
    v_cvt_pk_f16_f32 v91, v158, v159
    ds_write_b128 v180, v[88:91] offset:4096
    v_pk_fma_f32 v[160:161], v[136:137], v[152:153], v[144:145] neg_lo:[0,0,1] neg_hi:[0,0,1]
    v_pk_fma_f32 v[162:163], v[138:139], v[154:155], v[146:147] neg_lo:[0,0,1] neg_hi:[0,0,1]
    v_pk_fma_f32 v[164:165], v[140:141], v[156:157], v[148:149] neg_lo:[0,0,1] neg_hi:[0,0,1]
    v_pk_fma_f32 v[166:167], v[142:143], v[158:159], v[150:151] neg_lo:[0,0,1] neg_hi:[0,0,1]
    s_waitcnt lgkmcnt(3)
    v_cvt_pk_f16_f32 v92, v160, v161
    v_cvt_pk_f16_f32 v93, v162, v163
    v_cvt_pk_f16_f32 v94, v164, v165
    v_cvt_pk_f16_f32 v95, v166, v167
    ds_write_b128 v181, v[92:95] offset:5120
    v_pk_fma_f32 v[144:145], v[136:137], v[160:161], v[152:153] neg_lo:[0,0,1] neg_hi:[0,0,1]
    v_pk_fma_f32 v[146:147], v[138:139], v[162:163], v[154:155] neg_lo:[0,0,1] neg_hi:[0,0,1]
    v_pk_fma_f32 v[148:149], v[140:141], v[164:165], v[156:157] neg_lo:[0,0,1] neg_hi:[0,0,1]
    v_pk_fma_f32 v[150:151], v[142:143], v[166:167], v[158:159] neg_lo:[0,0,1] neg_hi:[0,0,1]
    s_waitcnt lgkmcnt(3)
    v_cvt_pk_f16_f32 v96, v144, v145
    v_cvt_pk_f16_f32 v97, v146, v147
    v_cvt_pk_f16_f32 v98, v148, v149
    v_cvt_pk_f16_f32 v99, v150, v151
    ds_write_b128 v182, v[96:99] offset:6144
    v_pk_fma_f32 v[152:153], v[136:137], v[144:145], v[160:161] neg_lo:[0,0,1] neg_hi:[0,0,1]
    v_pk_fma_f32 v[154:155], v[138:139], v[146:147], v[162:163] neg_lo:[0,0,1] neg_hi:[0,0,1]
    v_pk_fma_f32 v[156:157], v[140:141], v[148:149], v[164:165] neg_lo:[0,0,1] neg_hi:[0,0,1]
    v_pk_fma_f32 v[158:159], v[142:143], v[150:151], v[166:167] neg_lo:[0,0,1] neg_hi:[0,0,1]
    s_waitcnt lgkmcnt(3)
    v_cvt_pk_f16_f32 v100, v152, v153
    v_cvt_pk_f16_f32 v101, v154, v155
    v_cvt_pk_f16_f32 v102, v156, v157
    v_cvt_pk_f16_f32 v103, v158, v159
    ds_write_b128 v183, v[100:103] offset:7168
    s_cmp_eq_u32 s3, 0
    s_cbranch_scc0 KC_b0
    s_mov_b32 s47, 30000
    s_and_b32 s46, s2, 15
    s_lshl_b32 s46, s46, 7
    s_add_u32 s46, s46, 2232324
KC_rwb:
    s_load_dword s49, s[4:5], s46 glc
    s_waitcnt lgkmcnt(0)
    s_cmp_eq_u32 s49, 1
    s_cbranch_scc1 KC_rgb
    s_sub_u32 s47, s47, 1
    s_cbranch_scc0 KC_rwb
KC_rgb:
KC_b0:
    s_barrier
    s_waitcnt lgkmcnt(0)
    s_mov_b32 s8, s4
    s_mov_b32 s9, s5
    s_mov_b32 s10, 0x300000
    s_mov_b32 s11, 0x20000
    buffer_load_dwordx4 v184, s[8:11], s24 offen offset:0 sc1 lds
    buffer_load_dwordx4 v185, s[8:11], s24 offen offset:1024 sc1 lds
    buffer_load_dwordx4 v186, s[8:11], s24 offen offset:2048 sc1 lds
    buffer_load_dwordx4 v187, s[8:11], s24 offen offset:3072 sc1 lds
    s_add_u32 s24, s24, 4096
    s_add_u32 m0, s26, 4096
    s_nop 0
    buffer_load_dwordx4 v188, s[8:11], s24 offen offset:0 sc1 lds
    buffer_load_dwordx4 v189, s[8:11], s24 offen offset:1024 sc1 lds
    buffer_load_dwordx4 v190, s[8:11], s24 offen offset:2048 sc1 lds
    buffer_load_dwordx4 v191, s[8:11], s24 offen offset:3072 sc1 lds
    s_and_b32 s60, s2, 2
    s_lshl_b32 s60, s60, 1
    s_bfe_u32 s22, s2, 0x20003
    s_add_u32 s60, s60, s22
    s_lshl_b32 s60, s60, 1
    s_and_b32 s22, s2, 1
    s_add_u32 s60, s60, s22
    s_lshr_b32 s66, s2, 5
    s_bfe_u32 s61, s2, 0x10002
    s_lshl_b32 s61, s61, 3
    s_add_u32 s61, s61, s66
    s_lshl_b32 s61, s61, 1
    s_and_b32 s22, s60, 1
    s_add_u32 s61, s61, s22
    s_add_u32 s12, s4, 0x400000
    s_addc_u32 s13, s5, 0
    s_mov_b32 s14, 0x540000
    s_mov_b32 s15, 0x20000
    s_add_u32 s16, s4, 0xa00000
    s_addc_u32 s17, s5, 0
    s_mov_b32 s18, 0x400000
    s_mov_b32 s19, 0x20000
    s_mul_i32 s62, s60, 229376
    s_lshl_b32 s22, s3, 15
    s_add_u32 s62, s62, s22
    s_lshl_b32 s63, s66, 12
    s_add_u32 s64, s62, s63
    s_and_b32 s67, s60, 6
    s_add_u32 s67, s67, s3
    s_and_b32 s67, s67, 7
    s_lshl_b32 s22, s21, 1
    s_add_u32 s70, s70, s22
    s_and_b32 s70, s70, 7
    s_mul_i32 s65, s70, 229376
    s_mul_i32 s22, s20, 28672
    s_add_u32 s65, s65, s22
    s_add_u32 s65, s65, 3670016
    s_mov_b32 s58, 0xffff0000
    s_mov_b32 s59, 0x3f803f80
    s_cmp_ge_u32 s3, 4
    s_cbranch_scc1 KC_hi
    v_and_b32 v14, 15, v3
    v_lshlrev_b32 v15, 10, v3
    s_lshl_b32 s46, s36, 15
    v_add_u32 v15, s46, v15
    v_and_b32 v16, 19, v3
    v_bfe_u32 v17, v3, 2, 1
    v_lshl_or_b32 v16, v17, 3, v16
    v_bfe_u32 v17, v3, 3, 1
    v_lshl_or_b32 v16, v17, 2, v16
    v_and_b32 v17, 15, v16
    v_lshlrev_b32 v18, 10, v16
    s_lshl_b32 s46, s37, 15
    s_add_u32 s46, s46, 65536
    v_add_u32 v18, s46, v18
    v_xor_b32 v14, v14, v4
    v_xor_b32 v17, v17, v4
    v_xor_b32 v19, 0, v14
    v_lshl_add_u32 v112, v19, 4, v15
    v_xor_b32 v19, 0, v17
    v_lshl_add_u32 v120, v19, 4, v18
    v_xor_b32 v19, 2, v14
    v_lshl_add_u32 v113, v19, 4, v15
    v_xor_b32 v19, 2, v17
    v_lshl_add_u32 v121, v19, 4, v18
    v_xor_b32 v19, 4, v14
    v_lshl_add_u32 v114, v19, 4, v15
    v_xor_b32 v19, 4, v17
    v_lshl_add_u32 v122, v19, 4, v18
    v_xor_b32 v19, 6, v14
    v_lshl_add_u32 v115, v19, 4, v15
    v_xor_b32 v19, 6, v17
    v_lshl_add_u32 v123, v19, 4, v18
    v_xor_b32 v19, 8, v14
    v_lshl_add_u32 v116, v19, 4, v15
    v_xor_b32 v19, 8, v17
    v_lshl_add_u32 v124, v19, 4, v18
    v_xor_b32 v19, 10, v14
    v_lshl_add_u32 v117, v19, 4, v15
    v_xor_b32 v19, 10, v17
    v_lshl_add_u32 v125, v19, 4, v18
    v_xor_b32 v19, 12, v14
    v_lshl_add_u32 v118, v19, 4, v15
    v_xor_b32 v19, 12, v17
    v_lshl_add_u32 v126, v19, 4, v18
    v_xor_b32 v19, 14, v14
    v_lshl_add_u32 v119, v19, 4, v15
    v_xor_b32 v19, 14, v17
    v_lshl_add_u32 v127, v19, 4, v18
    s_lshl_b32 s46, s3, 11
    s_add_u32 s46, s46, 131072
    v_add_u32 v19, s46, v5
    s_waitcnt vmcnt(0) lgkmcnt(0)
    s_barrier
    ds_read_b128 v[32:35], v112 offset:0
    ds_read_b128 v[48:51], v120 offset:0
    ds_read_b128 v[36:39], v113 offset:0
    ds_read_b128 v[52:55], v121 offset:0
    ds_read_b128 v[40:43], v114 offset:0
    ds_read_b128 v[56:59], v122 offset:0
    ds_read_b128 v[44:47], v115 offset:0
    ds_read_b128 v[60:63], v123 offset:0
    s_waitcnt lgkmcnt(6)
    v_mfma_f32_32x32x16_f16 v[64:79], v[32:35], v[48:51], 0
    ds_read_b128 v[32:35], v116 offset:0
    ds_read_b128 v[48:51], v124 offset:0
    s_waitcnt lgkmcnt(6)
    v_mfma_f32_32x32x16_f16 v[64:79], v[36:39], v[52:55], v[64:79]
    ds_read_b128 v[36:39], v117 offset:0
    ds_read_b128 v[52:55], v125 offset:0
    s_waitcnt lgkmcnt(6)
    v_mfma_f32_32x32x16_f16 v[64:79], v[40:43], v[56:59], v[64:79]
    ds_read_b128 v[40:43], v118 offset:0
    ds_read_b128 v[56:59], v126 offset:0
    s_waitcnt lgkmcnt(6)
    v_mfma_f32_32x32x16_f16 v[64:79], v[44:47], v[60:63], v[64:79]
    ds_read_b128 v[44:47], v119 offset:0
    ds_read_b128 v[60:63], v127 offset:0
    s_waitcnt lgkmcnt(6)
    v_mfma_f32_32x32x16_f16 v[64:79], v[32:35], v[48:51], v[64:79]
    ds_read_b128 v[32:35], v112 offset:256
    ds_read_b128 v[48:51], v120 offset:256
    s_waitcnt lgkmcnt(6)
    v_mfma_f32_32x32x16_f16 v[64:79], v[36:39], v[52:55], v[64:79]
    ds_read_b128 v[36:39], v113 offset:256
    ds_read_b128 v[52:55], v121 offset:256
    s_waitcnt lgkmcnt(6)
    v_mfma_f32_32x32x16_f16 v[64:79], v[40:43], v[56:59], v[64:79]
    ds_read_b128 v[40:43], v114 offset:256
    ds_read_b128 v[56:59], v122 offset:256
    s_waitcnt lgkmcnt(6)
    v_mfma_f32_32x32x16_f16 v[64:79], v[44:47], v[60:63], v[64:79]
    ds_read_b128 v[44:47], v115 offset:256
    ds_read_b128 v[60:63], v123 offset:256
    s_waitcnt lgkmcnt(6)
    v_mfma_f32_32x32x16_f16 v[64:79], v[32:35], v[48:51], v[64:79]
    ds_read_b128 v[32:35], v116 offset:256
    ds_read_b128 v[48:51], v124 offset:256
    s_waitcnt lgkmcnt(6)
    v_mfma_f32_32x32x16_f16 v[64:79], v[36:39], v[52:55], v[64:79]
    ds_read_b128 v[36:39], v117 offset:256
    ds_read_b128 v[52:55], v125 offset:256
    s_waitcnt lgkmcnt(6)
    v_mfma_f32_32x32x16_f16 v[64:79], v[40:43], v[56:59], v[64:79]
    ds_read_b128 v[40:43], v118 offset:256
    ds_read_b128 v[56:59], v126 offset:256
    s_waitcnt lgkmcnt(6)
    v_mfma_f32_32x32x16_f16 v[64:79], v[44:47], v[60:63], v[64:79]
    ds_read_b128 v[44:47], v119 offset:256
    ds_read_b128 v[60:63], v127 offset:256
    s_waitcnt lgkmcnt(6)
    v_mfma_f32_32x32x16_f16 v[64:79], v[32:35], v[48:51], v[64:79]
    ds_read_b128 v[32:35], v112 offset:512
    ds_read_b128 v[48:51], v120 offset:512
    s_waitcnt lgkmcnt(6)
    v_mfma_f32_32x32x16_f16 v[64:79], v[36:39], v[52:55], v[64:79]
    ds_read_b128 v[36:39], v113 offset:512
    ds_read_b128 v[52:55], v121 offset:512
    s_waitcnt lgkmcnt(6)
    v_mfma_f32_32x32x16_f16 v[64:79], v[40:43], v[56:59], v[64:79]
    ds_read_b128 v[40:43], v114 offset:512
    ds_read_b128 v[56:59], v122 offset:512
    s_waitcnt lgkmcnt(6)
    v_mfma_f32_32x32x16_f16 v[64:79], v[44:47], v[60:63], v[64:79]
    ds_read_b128 v[44:47], v115 offset:512
    ds_read_b128 v[60:63], v123 offset:512
    s_waitcnt lgkmcnt(6)
    v_mfma_f32_32x32x16_f16 v[64:79], v[32:35], v[48:51], v[64:79]
    ds_read_b128 v[32:35], v116 offset:512
    ds_read_b128 v[48:51], v124 offset:512
    s_waitcnt lgkmcnt(6)
    v_mfma_f32_32x32x16_f16 v[64:79], v[36:39], v[52:55], v[64:79]
    ds_read_b128 v[36:39], v117 offset:512
    ds_read_b128 v[52:55], v125 offset:512
    s_waitcnt lgkmcnt(6)
    v_mfma_f32_32x32x16_f16 v[64:79], v[40:43], v[56:59], v[64:79]
    ds_read_b128 v[40:43], v118 offset:512
    ds_read_b128 v[56:59], v126 offset:512
    s_waitcnt lgkmcnt(6)
    v_mfma_f32_32x32x16_f16 v[64:79], v[44:47], v[60:63], v[64:79]
    ds_read_b128 v[44:47], v119 offset:512
    ds_read_b128 v[60:63], v127 offset:512
    s_waitcnt lgkmcnt(6)
    v_mfma_f32_32x32x16_f16 v[64:79], v[32:35], v[48:51], v[64:79]
    ds_read_b128 v[32:35], v112 offset:768
    ds_read_b128 v[48:51], v120 offset:768
    s_waitcnt lgkmcnt(6)
    v_mfma_f32_32x32x16_f16 v[64:79], v[36:39], v[52:55], v[64:79]
    ds_read_b128 v[36:39], v113 offset:768
    ds_read_b128 v[52:55], v121 offset:768
    s_waitcnt lgkmcnt(6)
    v_mfma_f32_32x32x16_f16 v[64:79], v[40:43], v[56:59], v[64:79]
    ds_read_b128 v[40:43], v114 offset:768
    ds_read_b128 v[56:59], v122 offset:768
    s_waitcnt lgkmcnt(6)
    v_mfma_f32_32x32x16_f16 v[64:79], v[44:47], v[60:63], v[64:79]
    ds_read_b128 v[44:47], v115 offset:768
    ds_read_b128 v[60:63], v123 offset:768
    s_waitcnt lgkmcnt(6)
    v_mfma_f32_32x32x16_f16 v[64:79], v[32:35], v[48:51], v[64:79]
    ds_read_b128 v[32:35], v116 offset:768
    ds_read_b128 v[48:51], v124 offset:768
    s_waitcnt lgkmcnt(6)
    v_mfma_f32_32x32x16_f16 v[64:79], v[36:39], v[52:55], v[64:79]
    ds_read_b128 v[36:39], v117 offset:768
    ds_read_b128 v[52:55], v125 offset:768
    s_waitcnt lgkmcnt(6)
    v_mfma_f32_32x32x16_f16 v[64:79], v[40:43], v[56:59], v[64:79]
    ds_read_b128 v[40:43], v118 offset:768
    ds_read_b128 v[56:59], v126 offset:768
    s_waitcnt lgkmcnt(6)
    v_mfma_f32_32x32x16_f16 v[64:79], v[44:47], v[60:63], v[64:79]
    ds_read_b128 v[44:47], v119 offset:768
    ds_read_b128 v[60:63], v127 offset:768
    s_waitcnt lgkmcnt(6)
    v_mfma_f32_32x32x16_f16 v[64:79], v[32:35], v[48:51], v[64:79]
    s_waitcnt lgkmcnt(4)
    v_mfma_f32_32x32x16_f16 v[64:79], v[36:39], v[52:55], v[64:79]
    s_waitcnt lgkmcnt(2)
    v_mfma_f32_32x32x16_f16 v[64:79], v[40:43], v[56:59], v[64:79]
    s_waitcnt lgkmcnt(0)
    v_mfma_f32_32x32x16_f16 v[64:79], v[44:47], v[60:63], v[64:79]
    s_nop 11
    v_cvt_pk_f16_f32 v24, v64, v65
    v_cvt_pk_f16_f32 v25, v66, v67
    v_cvt_pk_f16_f32 v26, v68, v69
    v_cvt_pk_f16_f32 v27, v70, v71
    v_cvt_pk_f16_f32 v28, v72, v73
    v_cvt_pk_f16_f32 v29, v74, v75
    v_cvt_pk_f16_f32 v30, v76, v77
    v_cvt_pk_f16_f32 v31, v78, v79
    ds_write_b128 v19, v[24:27]
    ds_write_b128 v19, v[28:31] offset:1024
    s_waitcnt lgkmcnt(0)
    s_barrier
    buffer_load_dwordx4 v[128:131], v5, s[12:15], s64 offen offset:0 sc1
    buffer_load_dwordx4 v[132:135], v5, s[12:15], s64 offen offset:1024 sc1
    buffer_load_dwordx4 v[136:139], v5, s[12:15], s64 offen offset:2048 sc1
    buffer_load_dwordx4 v[140:143], v5, s[12:15], s64 offen offset:3072 sc1
    s_add_u32 s63, s63, 4096
    s_and_b32 s63, s63, 0x7fff
    s_add_u32 s64, s62, s63
    buffer_load_dwordx4 v[144:147], v5, s[12:15], s64 offen offset:0 sc1
    buffer_load_dwordx4 v[148:151], v5, s[12:15], s64 offen offset:1024 sc1
    buffer_load_dwordx4 v[152:155], v5, s[12:15], s64 offen offset:2048 sc1
    buffer_load_dwordx4 v[156:159], v5, s[12:15], s64 offen offset:3072 sc1
    s_add_u32 s63, s63, 4096
    s_and_b32 s63, s63, 0x7fff
    s_add_u32 s64, s62, s63
    buffer_load_dwordx4 v[160:163], v5, s[12:15], s64 offen offset:0 sc1
    buffer_load_dwordx4 v[164:167], v5, s[12:15], s64 offen offset:1024 sc1
    buffer_load_dwordx4 v[168:171], v5, s[12:15], s64 offen offset:2048 sc1
    buffer_load_dwordx4 v[172:175], v5, s[12:15], s64 offen offset:3072 sc1
    s_add_u32 s63, s63, 4096
    s_and_b32 s63, s63, 0x7fff
    s_add_u32 s64, s62, s63
    buffer_load_dwordx4 v[176:179], v5, s[12:15], s64 offen offset:0 sc1
    buffer_load_dwordx4 v[180:183], v5, s[12:15], s64 offen offset:1024 sc1
    buffer_load_dwordx4 v[184:187], v5, s[12:15], s64 offen offset:2048 sc1
    buffer_load_dwordx4 v[188:191], v5, s[12:15], s64 offen offset:3072 sc1
    s_add_u32 s63, s63, 4096
    s_and_b32 s63, s63, 0x7fff
    s_add_u32 s64, s62, s63
    buffer_load_dwordx4 v[192:195], v5, s[12:15], s64 offen offset:0 sc1
    buffer_load_dwordx4 v[196:199], v5, s[12:15], s64 offen offset:1024 sc1
    buffer_load_dwordx4 v[200:203], v5, s[12:15], s64 offen offset:2048 sc1
    buffer_load_dwordx4 v[204:207], v5, s[12:15], s64 offen offset:3072 sc1
    s_add_u32 s63, s63, 4096
    s_and_b32 s63, s63, 0x7fff
    s_add_u32 s64, s62, s63
    buffer_load_dwordx4 v[208:211], v5, s[12:15], s64 offen offset:0 sc1
    buffer_load_dwordx4 v[212:215], v5, s[12:15], s64 offen offset:1024 sc1
    buffer_load_dwordx4 v[216:219], v5, s[12:15], s64 offen offset:2048 sc1
    buffer_load_dwordx4 v[220:223], v5, s[12:15], s64 offen offset:3072 sc1
    s_add_u32 s63, s63, 4096
    s_and_b32 s63, s63, 0x7fff
    s_add_u32 s64, s62, s63
    buffer_load_dwordx4 v[224:227], v5, s[12:15], s64 offen offset:0 sc1
    buffer_load_dwordx4 v[228:231], v5, s[12:15], s64 offen offset:1024 sc1
    buffer_load_dwordx4 v[232:235], v5, s[12:15], s64 offen offset:2048 sc1
    buffer_load_dwordx4 v[236:239], v5, s[12:15], s64 offen offset:3072 sc1
    s_add_u32 s63, s63, 4096
    s_and_b32 s63, s63, 0x7fff
    s_add_u32 s64, s62, s63
    buffer_load_dwordx4 v[240:243], v5, s[12:15], s64 offen offset:0 sc1
    buffer_load_dwordx4 v[244:247], v5, s[12:15], s64 offen offset:1024 sc1
    buffer_load_dwordx4 v[248:251], v5, s[12:15], s64 offen offset:2048 sc1
    buffer_load_dwordx4 v[252:255], v5, s[12:15], s64 offen offset:3072 sc1
    s_branch KC_ffn
KC_hi:
    s_setprio 1
    s_cmp_eq_u32 s3, 7
    s_cbranch_scc0 KC_b1h
    v_mov_b32 v10, 157952
    v_and_b32 v12, 3, v2
    v_min_u32 v12, 2, v12
    v_lshlrev_b32 v12, 4, v12
    v_lshrrev_b32 v13, 2, v2
    v_lshl_add_u32 v12, v13, 7, v12
    s_mov_b32 s46, 2228224
    s_mov_b32 s47, 30000
KC_gw2:
    buffer_load_dwordx4 v[192:195], v12, s[8:11], s46 offen sc1
    s_waitcnt vmcnt(0)
    v_and_b32 v192, v192, v193
    v_and_b32 v194, v194, v195
    v_and_b32 v192, v192, v194
    v_cmp_ne_u32 vcc, 1, v192
    s_cbranch_vccz KC_gg2
    s_sub_u32 s47, s47, 1
    s_cbranch_scc0 KC_gw2
KC_gg2:
    v_mov_b32 v12, 1
    ds_write_b32 v10, v12 offset:20
KC_b1h:
    s_waitcnt vmcnt(0) lgkmcnt(0)
KC_b1h2:
    s_barrier
    s_lshl_b32 s39, s20, 8
    s_lshl_b32 s44, s37, 7
    s_add_u32 s44, s39, s44
    s_add_u32 s44, s44, 2101248
    v_lshlrev_b32 v12, 5, v4
    buffer_load_dwordx4 v[104:107], v12, s[8:11], s44 offen offset:0 sc1
    buffer_load_dwordx4 v[108:111], v12, s[8:11], s44 offen offset:16 sc1
    buffer_load_dwordx4 v[112:115], v12, s[8:11], s44 offen offset:64 sc1
    buffer_load_dwordx4 v[116:119], v12, s[8:11], s44 offen offset:80 sc1
    s_lshl_b32 s39, s20, 8
    s_lshl_b32 s44, s37, 7
    s_add_u32 s44, s39, s44
    s_add_u32 s44, s44, 2103296
    v_lshlrev_b32 v1, 5, v4
    buffer_load_dwordx4 v[56:59], v1, s[8:11], s44 offen offset:0 sc1
    buffer_load_dwordx4 v[60:63], v1, s[8:11], s44 offen offset:16 sc1
    buffer_load_dwordx4 v[64:67], v1, s[8:11], s44 offen offset:64 sc1
    buffer_load_dwordx4 v[68:71], v1, s[8:11], s44 offen offset:80 sc1
    buffer_load_dwordx4 v[72:75], v1, s[8:11], s44 offen offset:2048 sc1
    buffer_load_dwordx4 v[76:79], v1, s[8:11], s44 offen offset:2064 sc1
    buffer_load_dwordx4 v[80:83], v1, s[8:11], s44 offen offset:2112 sc1
    buffer_load_dwordx4 v[84:87], v1, s[8:11], s44 offen offset:2128 sc1
    s_cmp_eq_u32 s3, 7
    s_cbranch_scc0 KC_nosl
    s_cmp_eq_u32 s21, 0
    s_cbranch_scc0 KC_nosl2
    v_lshlrev_b32 v8, 2, v2
    s_lshl_b32 s39, s20, 8
    s_add_u32 s39, s39, 2113536
    buffer_load_dword v128, v8, s[8:11], s39 offen offset:0 sc1
    buffer_load_dword v129, v8, s[8:11], s39 offen offset:2048 sc1
    s_add_u32 s39, s39, 4096
    buffer_load_dword v130, v8, s[8:11], s39 offen offset:0 sc1
    buffer_load_dword v131, v8, s[8:11], s39 offen offset:2048 sc1
    s_add_u32 s39, s39, 4096
    buffer_load_dword v132, v8, s[8:11], s39 offen offset:0 sc1
    buffer_load_dword v133, v8, s[8:11], s39 offen offset:2048 sc1
    s_add_u32 s39, s39, 4096
    buffer_load_dword v134, v8, s[8:11], s39 offen offset:0 sc1
    buffer_load_dword v135, v8, s[8:11], s39 offen offset:2048 sc1
    s_add_u32 s39, s39, 4096
    buffer_load_dword v136, v8, s[8:11], s39 offen offset:0 sc1
    buffer_load_dword v137, v8, s[8:11], s39 offen offset:2048 sc1
    s_add_u32 s39, s39, 4096
    buffer_load_dword v138, v8, s[8:11], s39 offen offset:0 sc1
    buffer_load_dword v139, v8, s[8:11], s39 offen offset:2048 sc1
    s_add_u32 s39, s39, 4096
    buffer_load_dword v140, v8, s[8:11], s39 offen offset:0 sc1
    buffer_load_dword v141, v8, s[8:11], s39 offen offset:2048 sc1
    s_add_u32 s39, s39, 4096
    buffer_load_dword v142, v8, s[8:11], s39 offen offset:0 sc1
    buffer_load_dword v143, v8, s[8:11], s39 offen offset:2048 sc1
    s_add_u32 s39, s39, 4096
KC_nosl2:
KC_nosl:
    v_lshlrev_b32 v13, 10, v4
    v_lshl_add_u32 v13, v3, 4, v13
    s_lshl_b32 s45, s21, 16
    s_lshl_b32 s46, s20, 13
    s_add_u32 s45, s45, s46
    s_lshl_b32 s46, s37, 12
    s_add_u32 s45, s45, s46
    s_lshl_b32 s46, s36, 9
    s_add_u32 s45, s45, s46
    v_add_u32 v1, 131072, v5
    s_lshl_b32 s46, s20, 1
    s_add_u32 s46, s46, s37
    s_cmp_eq_u32 s46, 1
    s_cselect_b32 s46, 4096, 0
    v_cmp_eq_u32 vcc, 0, v3
    v_mov_b32 v6, s46
    s_nop 0
    v_cndmask_b32 v6, 0, v6, vcc
    v_add_u32 v6, v6, v1
    s_cmp_eq_u32 s21, 0
    s_cbranch_scc0 KC_mdone
    s_cmp_eq_u32 s3, 7
    s_cbranch_scc0 KC_mdone
    s_waitcnt vmcnt(0)
    v_add_f32 v128, v128, v136
    v_add_f32 v129, v129, v137
    v_add_f32 v130, v130, v138
    v_add_f32 v131, v131, v139
    v_add_f32 v132, v132, v140
    v_add_f32 v133, v133, v141
    v_add_f32 v134, v134, v142
    v_add_f32 v135, v135, v143
    v_add_f32 v128, v128, v132
    v_add_f32 v129, v129, v133
    v_add_f32 v130, v130, v134
    v_add_f32 v131, v131, v135
    v_add_f32 v128, v128, v130
    v_add_f32 v129, v129, v131
    v_add_f32 v128, v128, v129
    v_lshlrev_b32 v8, 2, v2
    v_add_u32 v8, 157696, v8
    ds_write_b32 v8, v128
    s_waitcnt lgkmcnt(0)
KC_mdone:
    s_cmp_eq_u32 s37, 0
    s_cbranch_scc0 KC_xum
    v_lshlrev_b32 v16, 16, v120
    v_and_b32 v17, s58, v120
    v_lshlrev_b32 v18, 16, v121
    v_and_b32 v19, s58, v121
    v_lshlrev_b32 v20, 16, v122
    v_and_b32 v21, s58, v122
    v_lshlrev_b32 v22, 16, v123
    v_and_b32 v23, s58, v123
    v_lshlrev_b32 v24, 16, v124
    v_and_b32 v25, s58, v124
    v_lshlrev_b32 v26, 16, v125
    v_and_b32 v27, s58, v125
    v_lshlrev_b32 v28, 16, v126
    v_and_b32 v29, s58, v126
    v_lshlrev_b32 v30, 16, v127
    v_and_b32 v31, s58, v127
    s_branch KC_xud
KC_xum:
    v_lshlrev_b32 v16, 16, v14
    v_and_b32 v17, s58, v123
    v_lshlrev_b32 v18, 16, v123
    v_and_b32 v19, s58, v122
    v_lshlrev_b32 v20, 16, v122
    v_and_b32 v21, s58, v121
    v_lshlrev_b32 v22, 16, v121
    v_and_b32 v23, s58, v120
    v_lshlrev_b32 v24, 16, v15
    v_and_b32 v25, s58, v127
    v_lshlrev_b32 v26, 16, v127
    v_and_b32 v27, s58, v126
    v_lshlrev_b32 v28, 16, v126
    v_and_b32 v29, s58, v125
    v_lshlrev_b32 v30, 16, v125
    v_and_b32 v31, s58, v124
KC_xud:
    s_cmp_eq_u32 s3, 7
    s_cbranch_scc1 KC_nohg
    buffer_load_dwordx4 v[128:131], v5, s[12:15], s64 offen offset:0 sc1
    buffer_load_dwordx4 v[132:135], v5, s[12:15], s64 offen offset:1024 sc1
    buffer_load_dwordx4 v[136:139], v5, s[12:15], s64 offen offset:2048 sc1
    buffer_load_dwordx4 v[140:143], v5, s[12:15], s64 offen offset:3072 sc1
    s_add_u32 s63, s63, 4096
    s_and_b32 s63, s63, 0x7fff
    s_add_u32 s64, s62, s63
    buffer_load_dwordx4 v[144:147], v5, s[12:15], s64 offen offset:0 sc1
    buffer_load_dwordx4 v[148:151], v5, s[12:15], s64 offen offset:1024 sc1
    buffer_load_dwordx4 v[152:155], v5, s[12:15], s64 offen offset:2048 sc1
    buffer_load_dwordx4 v[156:159], v5, s[12:15], s64 offen offset:3072 sc1
    s_add_u32 s63, s63, 4096
    s_and_b32 s63, s63, 0x7fff
    s_add_u32 s64, s62, s63
    buffer_load_dwordx4 v[160:163], v5, s[12:15], s64 offen offset:0 sc1
    buffer_load_dwordx4 v[164:167], v5, s[12:15], s64 offen offset:1024 sc1
    buffer_load_dwordx4 v[168:171], v5, s[12:15], s64 offen offset:2048 sc1
    buffer_load_dwordx4 v[172:175], v5, s[12:15], s64 offen offset:3072 sc1
    s_add_u32 s63, s63, 4096
    s_and_b32 s63, s63, 0x7fff
    s_add_u32 s64, s62, s63
KC_nohg:
    s_lshl_b32 s46, s21, 3
    s_add_u32 s46, s46, s20
    s_lshl_b32 s47, s46, 10
    s_and_b32 s44, s3, 3
    s_lshl_b32 s39, s44, 8
    s_add_u32 s47, s47, s39
    s_add_u32 s47, s47, 2621440
    s_lshl_b32 s46, s46, 7
    s_lshl_b32 s44, s44, 2
    s_add_u32 s46, s46, s44
    s_add_u32 s46, s46, 2162688
    v_lshlrev_b32 v12, 3, v3
    v_lshl_add_u32 v12, v4, 2, v12
    v_mov_b32 v8, 0
    v_mov_b32 v9, 1
    v_mov_b32 v10, 0
    v_mov_b32 v11, 0
    s_barrier
    ds_read_b128 v[32:35], v6 offset:0
    ds_read_b128 v[36:39], v6 offset:1024
    ds_read_b128 v[40:43], v6 offset:2048
    ds_read_b128 v[44:47], v6 offset:3072
    ds_read_b128 v[48:51], v1 offset:4096
    ds_read_b128 v[52:55], v1 offset:5120
    ds_read_b128 v[120:123], v1 offset:6144
    ds_read_b128 v[124:127], v1 offset:7168
    s_waitcnt lgkmcnt(7)
    v_mfma_f32_32x32x16_f16 v[88:103], v[32:35], v[224:227], 0
    s_waitcnt lgkmcnt(6)
    v_mfma_f32_32x32x16_f16 v[88:103], v[36:39], v[228:231], v[88:103]
    s_waitcnt lgkmcnt(5)
    v_mfma_f32_32x32x16_f16 v[88:103], v[40:43], v[232:235], v[88:103]
    s_waitcnt lgkmcnt(4)
    v_mfma_f32_32x32x16_f16 v[88:103], v[44:47], v[236:239], v[88:103]
    s_waitcnt lgkmcnt(0)
    s_cmp_eq_u32 s20, 0
    s_cbranch_scc0 KC_nz
    s_mov_b32 exec_lo, 1
    s_mov_b32 exec_hi, 1
    v_mov_b32 v48, 0
    v_mov_b32 v49, 0
    v_mov_b32 v50, 0
    v_mov_b32 v51, 0
    v_mov_b32 v52, 0
    v_mov_b32 v53, 0
    v_mov_b32 v54, 0
    v_mov_b32 v55, 0
    v_mov_b32 v120, 0
    v_mov_b32 v121, 0
    v_mov_b32 v122, 0
    v_mov_b32 v123, 0
    v_mov_b32 v124, 0
    v_mov_b32 v125, 0
    v_mov_b32 v126, 0
    v_mov_b32 v127, 0
    s_mov_b64 exec, -1
    s_nop 1
KC_nz:
    v_mfma_f32_32x32x16_f16 v[88:103], v[48:51], v[240:243], v[88:103]
    v_mfma_f32_32x32x16_f16 v[88:103], v[52:55], v[244:247], v[88:103]
    v_mfma_f32_32x32x16_f16 v[88:103], v[120:123], v[248:251], v[88:103]
    v_mfma_f32_32x32x16_f16 v[88:103], v[124:127], v[252:255], v[88:103]
    s_or_b32 s39, s21, s36
    s_cmp_eq_u32 s39, 0
    s_cbranch_scc0 KC_nosh
    s_lshl_b32 s39, s37, 7
    s_add_u32 s39, s39, 157696
    v_lshl_add_u32 v6, v4, 5, s39
    ds_read_b128 v[32:35], v6 offset:0
    ds_read_b128 v[36:39], v6 offset:16
    ds_read_b128 v[40:43], v6 offset:64
    ds_read_b128 v[44:47], v6 offset:80
    s_waitcnt lgkmcnt(0)
    s_mov_b32 exec_lo, 1
    s_mov_b32 exec_hi, 1
    v_fmamk_f32 v88, v32, 0x41000000, v88
    v_fmamk_f32 v89, v33, 0x41000000, v89
    v_fmamk_f32 v90, v34, 0x41000000, v90
    v_fmamk_f32 v91, v35, 0x41000000, v91
    v_fmamk_f32 v92, v36, 0x41000000, v92
    v_fmamk_f32 v93, v37, 0x41000000, v93
    v_fmamk_f32 v94, v38, 0x41000000, v94
    v_fmamk_f32 v95, v39, 0x41000000, v95
    v_fmamk_f32 v96, v40, 0x41000000, v96
    v_fmamk_f32 v97, v41, 0x41000000, v97
    v_fmamk_f32 v98, v42, 0x41000000, v98
    v_fmamk_f32 v99, v43, 0x41000000, v99
    v_fmamk_f32 v100, v44, 0x41000000, v100
    v_fmamk_f32 v101, v45, 0x41000000, v101
    v_fmamk_f32 v102, v46, 0x41000000, v102
    v_fmamk_f32 v103, v47, 0x41000000, v103
    s_mov_b64 exec, -1
KC_nosh:
    s_nop 7
    s_cmp_eq_u32 s3, 7
    s_cbranch_scc0 KC_gw7
    s_waitcnt vmcnt(0)
KC_gw7:
    s_waitcnt vmcnt(12)
    v_fmac_f32 v16, v104, v88
    v_fmac_f32 v17, v105, v89
    v_fmac_f32 v18, v106, v90
    v_fmac_f32 v19, v107, v91
    v_fmac_f32 v20, v108, v92
    v_fmac_f32 v21, v109, v93
    v_fmac_f32 v22, v110, v94
    v_fmac_f32 v23, v111, v95
    v_fmac_f32 v24, v112, v96
    v_fmac_f32 v25, v113, v97
    v_fmac_f32 v26, v114, v98
    v_fmac_f32 v27, v115, v99
    v_fmac_f32 v28, v116, v100
    v_fmac_f32 v29, v117, v101
    v_fmac_f32 v30, v118, v102
    v_fmac_f32 v31, v119, v103
    v_cvt_pk_bf16_f32 v32, v16, v17
    v_cvt_pk_bf16_f32 v33, v18, v19
    v_cvt_pk_bf16_f32 v34, v20, v21
    v_cvt_pk_bf16_f32 v35, v22, v23
    v_cvt_pk_bf16_f32 v36, v24, v25
    v_cvt_pk_bf16_f32 v37, v26, v27
    v_cvt_pk_bf16_f32 v38, v28, v29
    v_cvt_pk_bf16_f32 v39, v30, v31
    v_dot2c_f32_bf16 v10, s59, v32
    v_dot2c_f32_bf16 v11, v32, v32
    v_dot2c_f32_bf16 v10, s59, v33
    v_dot2c_f32_bf16 v11, v33, v33
    v_dot2c_f32_bf16 v10, s59, v34
    v_dot2c_f32_bf16 v11, v34, v34
    v_dot2c_f32_bf16 v10, s59, v35
    v_dot2c_f32_bf16 v11, v35, v35
    v_dot2c_f32_bf16 v10, s59, v36
    v_dot2c_f32_bf16 v11, v36, v36
    v_dot2c_f32_bf16 v10, s59, v37
    v_dot2c_f32_bf16 v11, v37, v37
    v_dot2c_f32_bf16 v10, s59, v38
    v_dot2c_f32_bf16 v11, v38, v38
    v_dot2c_f32_bf16 v10, s59, v39
    v_dot2c_f32_bf16 v11, v39, v39
    s_nop 2
    v_permlane32_swap_b32 v10, v11
    v_add_f32 v10, v10, v11
    v_min_u32 v10, -2, v10
    s_add_u32 s39, s47, 0x40000
    buffer_store_dword v10, v12, s[8:11], s39 offen
    v_lshlrev_b32 v16, 16, v32
    v_and_b32 v17, s58, v32
    v_lshlrev_b32 v18, 16, v33
    v_and_b32 v19, s58, v33
    v_lshlrev_b32 v20, 16, v34
    v_and_b32 v21, s58, v34
    v_lshlrev_b32 v22, 16, v35
    v_and_b32 v23, s58, v35
    v_lshlrev_b32 v24, 16, v36
    v_and_b32 v25, s58, v36
    v_lshlrev_b32 v26, 16, v37
    v_and_b32 v27, s58, v37
    v_lshlrev_b32 v28, 16, v38
    v_and_b32 v29, s58, v38
    v_lshlrev_b32 v30, 16, v39
    v_and_b32 v31, s58, v39
    v_lshlrev_b32 v6, 3, v3
    v_lshl_add_u32 v6, v4, 9, v6
    s_lshl_b32 s39, s21, 13
    s_lshl_b32 s44, s36, 8
    s_add_u32 s39, s39, s44
    s_add_u32 s39, s39, 2883584
    s_add_u32 s44, s39, 4096
    s_waitcnt vmcnt(0)
    buffer_load_dwordx2 v[88:89], v6, s[8:11], s39 offen offset:0 sc1
    buffer_load_dwordx2 v[90:91], v6, s[8:11], s39 offen offset:1024 sc1
    buffer_load_dwordx2 v[92:93], v6, s[8:11], s39 offen offset:2048 sc1
    buffer_load_dwordx2 v[94:95], v6, s[8:11], s39 offen offset:3072 sc1
    buffer_load_dwordx2 v[96:97], v6, s[8:11], s44 offen offset:0 sc1
    buffer_load_dwordx2 v[98:99], v6, s[8:11], s44 offen offset:1024 sc1
    buffer_load_dwordx2 v[100:101], v6, s[8:11], s44 offen offset:2048 sc1
    buffer_load_dwordx2 v[102:103], v6, s[8:11], s44 offen offset:3072 sc1
    buffer_store_dword v10, v12, s[8:11], s47 offen sc1
    buffer_store_dwordx4 v[32:35], v13, s[16:19], s45 offen sc1
    buffer_store_dwordx4 v[36:39], v13, s[16:19], s45 offen offset:2048 sc1
    s_mov_b32 s47, 30000
    s_waitcnt vmcnt(3)
    s_branch KC_sgc
KC_sg:
    buffer_load_dwordx2 v[88:89], v6, s[8:11], s39 offen offset:0 sc1
    buffer_load_dwordx2 v[90:91], v6, s[8:11], s39 offen offset:1024 sc1
    buffer_load_dwordx2 v[92:93], v6, s[8:11], s39 offen offset:2048 sc1
    buffer_load_dwordx2 v[94:95], v6, s[8:11], s39 offen offset:3072 sc1
    buffer_load_dwordx2 v[96:97], v6, s[8:11], s44 offen offset:0 sc1
    buffer_load_dwordx2 v[98:99], v6, s[8:11], s44 offen offset:1024 sc1
    buffer_load_dwordx2 v[100:101], v6, s[8:11], s44 offen offset:2048 sc1
    buffer_load_dwordx2 v[102:103], v6, s[8:11], s44 offen offset:3072 sc1
    s_waitcnt vmcnt(0)
KC_sgc:
    v_max3_u32 v104, v88, v89, v90
    v_max3_u32 v105, v91, v92, v93
    v_max3_u32 v106, v94, v95, v96
    v_max3_u32 v107, v97, v98, v99
    v_max3_u32 v108, v100, v101, v102
    v_max3_u32 v104, v104, v105, v103
    v_max3_u32 v106, v106, v107, v108
    v_max_u32 v104, v104, v106
    v_cmp_eq_u32 vcc, -1, v104
    s_cbranch_vccz KC_sgd
    s_cmp_eq_u32 s47, 29996
    s_cselect_b32 s38, 0x40000, 0
    s_sub_u32 s39, s39, s38
    s_sub_u32 s44, s44, s38
    s_sub_u32 s47, s47, 1
    s_cbranch_scc0 KC_sg
KC_sgd:
    v_pk_add_f32 v[88:89], v[88:89], v[96:97]
    v_pk_add_f32 v[90:91], v[90:91], v[98:99]
    v_pk_add_f32 v[92:93], v[92:93], v[100:101]
    v_pk_add_f32 v[94:95], v[94:95], v[102:103]
    v_pk_add_f32 v[88:89], v[88:89], v[92:93]
    v_pk_add_f32 v[90:91], v[90:91], v[94:95]
    v_pk_add_f32 v[88:89], v[88:89], v[90:91]
    v_mov_b32 v90, v88
    v_mov_b32 v91, v89
    s_nop 0
    v_permlane32_swap_b32 v88, v90
    v_permlane32_swap_b32 v89, v91
    v_pk_add_f32 v[88:89], v[88:89], v[90:91]
    v_mul_f32 v88, 0x3b000000, v88
    v_mul_f32 v89, 0x3b000000, v89
    v_fma_f32 v89, -v88, v88, v89
    v_max_f32 v89, 0, v89
    v_add_f32 v89, 0x3727c5ac, v89
    v_rsq_f32 v90, v89
    s_nop 0
    v_mul_f32 v91, -v88, v90
    v_pk_fma_f32 v[16:17], v[16:17], v[90:91], v[90:91] op_sel:[0,0,1] op_sel_hi:[1,0,1]
    v_pk_fma_f32 v[18:19], v[18:19], v[90:91], v[90:91] op_sel:[0,0,1] op_sel_hi:[1,0,1]
    v_pk_fma_f32 v[20:21], v[20:21], v[90:91], v[90:91] op_sel:[0,0,1] op_sel_hi:[1,0,1]
    v_pk_fma_f32 v[22:23], v[22:23], v[90:91], v[90:91] op_sel:[0,0,1] op_sel_hi:[1,0,1]
    v_pk_fma_f32 v[24:25], v[24:25], v[90:91], v[90:91] op_sel:[0,0,1] op_sel_hi:[1,0,1]
    v_pk_fma_f32 v[26:27], v[26:27], v[90:91], v[90:91] op_sel:[0,0,1] op_sel_hi:[1,0,1]
    v_pk_fma_f32 v[28:29], v[28:29], v[90:91], v[90:91] op_sel:[0,0,1] op_sel_hi:[1,0,1]
    v_pk_fma_f32 v[30:31], v[30:31], v[90:91], v[90:91] op_sel:[0,0,1] op_sel_hi:[1,0,1]
    v_pk_fma_f32 v[16:17], v[16:17], v[72:73], v[56:57]
    v_pk_fma_f32 v[18:19], v[18:19], v[74:75], v[58:59]
    v_pk_fma_f32 v[20:21], v[20:21], v[76:77], v[60:61]
    v_pk_fma_f32 v[22:23], v[22:23], v[78:79], v[62:63]
    v_pk_fma_f32 v[24:25], v[24:25], v[80:81], v[64:65]
    v_pk_fma_f32 v[26:27], v[26:27], v[82:83], v[66:67]
    v_pk_fma_f32 v[28:29], v[28:29], v[84:85], v[68:69]
    v_pk_fma_f32 v[30:31], v[30:31], v[86:87], v[70:71]
    v_cvt_pk_bf16_f32 v40, v16, v17
    v_cvt_pk_bf16_f32 v41, v18, v19
    v_cvt_pk_bf16_f32 v42, v20, v21
    v_cvt_pk_bf16_f32 v43, v22, v23
    v_cvt_pk_bf16_f32 v44, v24, v25
    v_cvt_pk_bf16_f32 v45, v26, v27
    v_cvt_pk_bf16_f32 v46, v28, v29
    v_cvt_pk_bf16_f32 v47, v30, v31
    s_add_u32 s45, s45, 2097152
    buffer_store_dwordx4 v[40:43], v13, s[16:19], s45 offen sc1
    buffer_store_dwordx4 v[44:47], v13, s[16:19], s45 offen offset:2048 sc1
    s_mov_b64 exec, 1
    s_waitcnt vmcnt(0)
    buffer_store_dword v9, v8, s[8:11], s46 offen sc1
    s_mov_b64 exec, -1
    s_cmp_eq_u32 s3, 7
    s_cbranch_scc1 KC_w7a
    buffer_load_dwordx4 v[176:179], v5, s[12:15], s64 offen offset:0 sc1
    buffer_load_dwordx4 v[180:183], v5, s[12:15], s64 offen offset:1024 sc1
    buffer_load_dwordx4 v[184:187], v5, s[12:15], s64 offen offset:2048 sc1
    buffer_load_dwordx4 v[188:191], v5, s[12:15], s64 offen offset:3072 sc1
    s_add_u32 s63, s63, 4096
    s_and_b32 s63, s63, 0x7fff
    s_add_u32 s64, s62, s63
    buffer_load_dwordx4 v[192:195], v5, s[12:15], s64 offen offset:0 sc1
    buffer_load_dwordx4 v[196:199], v5, s[12:15], s64 offen offset:1024 sc1
    buffer_load_dwordx4 v[200:203], v5, s[12:15], s64 offen offset:2048 sc1
    buffer_load_dwordx4 v[204:207], v5, s[12:15], s64 offen offset:3072 sc1
    s_add_u32 s63, s63, 4096
    s_and_b32 s63, s63, 0x7fff
    s_add_u32 s64, s62, s63
    buffer_load_dwordx4 v[208:211], v5, s[12:15], s64 offen offset:0 sc1
    buffer_load_dwordx4 v[212:215], v5, s[12:15], s64 offen offset:1024 sc1
    buffer_load_dwordx4 v[216:219], v5, s[12:15], s64 offen offset:2048 sc1
    buffer_load_dwordx4 v[220:223], v5, s[12:15], s64 offen offset:3072 sc1
    s_add_u32 s63, s63, 4096
    s_and_b32 s63, s63, 0x7fff
    s_add_u32 s64, s62, s63
    buffer_load_dwordx4 v[224:227], v5, s[12:15], s64 offen offset:0 sc1
    buffer_load_dwordx4 v[228:231], v5, s[12:15], s64 offen offset:1024 sc1
    buffer_load_dwordx4 v[232:235], v5, s[12:15], s64 offen offset:2048 sc1
    buffer_load_dwordx4 v[236:239], v5, s[12:15], s64 offen offset:3072 sc1
    s_add_u32 s63, s63, 4096
    s_and_b32 s63, s63, 0x7fff
    s_add_u32 s64, s62, s63
    buffer_load_dwordx4 v[240:243], v5, s[12:15], s64 offen offset:0 sc1
    buffer_load_dwordx4 v[244:247], v5, s[12:15], s64 offen offset:1024 sc1
    buffer_load_dwordx4 v[248:251], v5, s[12:15], s64 offen offset:2048 sc1
    buffer_load_dwordx4 v[252:255], v5, s[12:15], s64 offen offset:3072 sc1
    s_branch KC_ffn
KC_w7a:
KC_ffn:
    s_and_b32 s20, s2, 1
    s_lshl_b32 s20, s20, 2
    s_bfe_u32 s22, s2, 0x20003
    s_add_u32 s20, s20, s22
    s_bfe_u32 s21, s2, 0x20001
    s_lshl_b32 s21, s21, 3
    s_lshr_b32 s24, s2, 5
    s_add_u32 s21, s21, s24
    s_lshl_b32 s70, s22, 1
    s_add_u32 s70, s70, s24
    s_add_u32 s70, s70, s3
    s_and_b32 s70, s70, 7
    s_mul_i32 s65, s70, 229376
    s_mul_i32 s22, s20, 28672
    s_add_u32 s65, s65, s22
    s_add_u32 s65, s65, 3670016
    s_add_u32 s48, s4, 0xe00000
    s_addc_u32 s49, s5, 0
    s_mov_b32 s50, 0x700000
    s_mov_b32 s51, 0x20000
    s_lshl_b32 s24, s61, 16
    s_lshl_b32 s25, s67, 13
    s_add_u32 s24, s24, s25
    s_add_u32 s24, s24, 2097152
    s_xor_b32 s25, s24, 0x10000
    s_sub_u32 s27, s67, s66
    s_and_b32 s27, s27, 7
    s_lshl_b32 s27, s27, 13
    s_lshl_b32 s52, s21, 3
    s_add_u32 s52, s52, s70
    s_mul_i32 s53, s52, 28672
    s_lshl_b32 s52, s52, 7
    s_and_b32 s22, s21, 1
    s_lshl_b32 s22, s22, 5
    s_add_u32 s52, s52, s22
    s_add_u32 s52, s52, 32768
    s_xor_b32 s23, s52, 32
    s_add_u32 s56, s4, 2162688
    s_addc_u32 s57, s5, 0
    s_and_b32 s22, s21, 1
    s_lshl_b32 s22, s22, 11
    v_add_u32 v14, s22, v5
    v_xor_b32 v15, 0x800, v14
    s_cmp_lt_u32 s3, 4
    s_cbranch_scc0 KC_nowd
KC_nowd:
    s_lshl_b32 s44, s61, 3
    s_add_u32 s44, s44, s67
    s_lshl_b32 s44, s44, 7
    s_xor_b32 s45, s44, 0x400
    s_mov_b32 s47, 30000
KC_polla:
    s_load_dwordx4 s[36:39], s[56:57], s44 glc
    s_waitcnt lgkmcnt(0)
    s_and_b64 s[36:37], s[36:37], s[38:39]
    s_and_b32 s36, s36, s37
    s_cmp_eq_u32 s36, 1
    s_cbranch_scc1 KC_gota
    s_sub_u32 s47, s47, 1
    s_cbranch_scc0 KC_polla
KC_gota:
    s_add_u32 m0, s27, 0
    s_nop 0
    buffer_load_dwordx4 v5, s[16:19], s24 offen offset:0 sc1 lds
    buffer_load_dwordx4 v5, s[16:19], s24 offen offset:1024 sc1 lds
    buffer_load_dwordx4 v5, s[16:19], s24 offen offset:2048 sc1 lds
    buffer_load_dwordx4 v5, s[16:19], s24 offen offset:3072 sc1 lds
    s_add_u32 m0, s27, 4096
    s_add_u32 s24, s24, 4096
    buffer_load_dwordx4 v5, s[16:19], s24 offen offset:0 sc1 lds
    buffer_load_dwordx4 v5, s[16:19], s24 offen offset:1024 sc1 lds
    buffer_load_dwordx4 v5, s[16:19], s24 offen offset:2048 sc1 lds
    buffer_load_dwordx4 v5, s[16:19], s24 offen offset:3072 sc1 lds
KC_n1d:
    v_lshlrev_b32 v7, 10, v4
    v_lshl_add_u32 v7, v3, 4, v7
    v_mov_b32 v8, 0
    v_mov_b32 v9, 1
    v_mov_b32 v10, 157952
    s_mov_b32 s32, 0xbdd2d3e8
    v_mov_b32 v11, 0xc0135761
    s_lshl_b32 s46, s61, 3
    s_lshr_b32 s47, s60, 1
    s_add_u32 s46, s46, s47
    s_xor_b32 s47, s46, 8
    s_mul_i32 s29, s46, 28672
    s_mul_i32 s31, s47, 28672
    s_lshl_b32 s30, s3, 1
    s_and_b32 s28, s60, 1
    s_add_u32 s30, s30, s28
    s_lshl_b32 s30, s30, 11
    s_add_u32 s29, s29, s30
    s_add_u32 s31, s31, s30
    s_lshl_b32 s28, s28, 3
    s_add_u32 s28, s28, s3
    s_lshl_b32 s28, s28, 2
    s_lshl_b32 s33, s46, 7
    s_add_u32 s33, s33, s28
    s_add_u32 s33, s33, 2195456
    s_xor_b32 s34, s33, 0x400
    s_waitcnt vmcnt(0) lgkmcnt(0)
    s_barrier
    s_cmp_lt_u32 s3, 4
    s_cbranch_scc1 KC_p1
    s_cmp_eq_u32 s3, 7
    s_cbranch_scc1 KC_nohw
KC_nohw:
    s_xor_b32 s24, s25, 0x8000
    s_xor_b32 s44, s45, 0x200
    s_mov_b32 s47, 30000
KC_pollb:
    s_load_dwordx4 s[36:39], s[56:57], s45 glc
    s_waitcnt lgkmcnt(0)
    s_and_b64 s[36:37], s[36:37], s[38:39]
    s_and_b32 s36, s36, s37
    s_cmp_eq_u32 s36, 1
    s_cbranch_scc1 KC_gotb
    s_sub_u32 s47, s47, 1
    s_cbranch_scc0 KC_pollb
KC_gotb:
    s_add_u32 m0, s27, 65536
    s_nop 0
    buffer_load_dwordx4 v5, s[16:19], s25 offen offset:0 sc1 lds
    buffer_load_dwordx4 v5, s[16:19], s25 offen offset:1024 sc1 lds
    buffer_load_dwordx4 v5, s[16:19], s25 offen offset:2048 sc1 lds
    buffer_load_dwordx4 v5, s[16:19], s25 offen offset:3072 sc1 lds
    s_add_u32 m0, s27, 69632
    s_add_u32 s25, s25, 4096
    buffer_load_dwordx4 v5, s[16:19], s25 offen offset:0 sc1 lds
    buffer_load_dwordx4 v5, s[16:19], s25 offen offset:1024 sc1 lds
    buffer_load_dwordx4 v5, s[16:19], s25 offen offset:2048 sc1 lds
    buffer_load_dwordx4 v5, s[16:19], s25 offen offset:3072 sc1 lds
    s_mov_b32 s47, 30000
KC_pollc:
    s_load_dwordx4 s[36:39], s[56:57], s44 glc
    s_waitcnt lgkmcnt(0)
    s_and_b64 s[36:37], s[36:37], s[38:39]
    s_and_b32 s36, s36, s37
    s_cmp_eq_u32 s36, 1
    s_cbranch_scc1 KC_gotc
    s_sub_u32 s47, s47, 1
    s_cbranch_scc0 KC_pollc
KC_gotc:
    s_xor_b32 s27, s27, 0x8000
    s_add_u32 m0, s27, 65536
    s_nop 0
    buffer_load_dwordx4 v5, s[16:19], s24 offen offset:0 sc1 lds
    buffer_load_dwordx4 v5, s[16:19], s24 offen offset:1024 sc1 lds
    buffer_load_dwordx4 v5, s[16:19], s24 offen offset:2048 sc1 lds
    buffer_load_dwordx4 v5, s[16:19], s24 offen offset:3072 sc1 lds
    s_add_u32 m0, s27, 69632
    s_add_u32 s24, s24, 4096
    buffer_load_dwordx4 v5, s[16:19], s24 offen offset:0 sc1 lds
    buffer_load_dwordx4 v5, s[16:19], s24 offen offset:1024 sc1 lds
    buffer_load_dwordx4 v5, s[16:19], s24 offen offset:2048 sc1 lds
    buffer_load_dwordx4 v5, s[16:19], s24 offen offset:3072 sc1 lds
    s_cmp_eq_u32 s3, 7
    s_cbranch_scc1 KC_w7b
    s_add_u32 s71, s65, 4096
    buffer_load_dwordx4 v[64:67], v15, s[12:15], s71 offen offset:0 sc1
    buffer_load_dwordx4 v[68:71], v15, s[12:15], s71 offen offset:1024 sc1
    s_add_u32 s71, s65, 8192
    buffer_load_dwordx4 v[72:75], v15, s[12:15], s71 offen offset:0 sc1
    buffer_load_dwordx4 v[76:79], v15, s[12:15], s71 offen offset:1024 sc1
    s_add_u32 s71, s65, 12288
    buffer_load_dwordx4 v[96:99], v15, s[12:15], s71 offen offset:0 sc1
    buffer_load_dwordx4 v[100:103], v15, s[12:15], s71 offen offset:1024 sc1
    s_add_u32 s71, s65, 16384
    buffer_load_dwordx4 v[104:107], v15, s[12:15], s71 offen offset:0 sc1
    buffer_load_dwordx4 v[108:111], v15, s[12:15], s71 offen offset:1024 sc1
    s_add_u32 s71, s65, 20480
    buffer_load_dwordx4 v[112:115], v15, s[12:15], s71 offen offset:0 sc1
    buffer_load_dwordx4 v[116:119], v15, s[12:15], s71 offen offset:1024 sc1
    s_add_u32 s71, s65, 24576
    buffer_load_dwordx4 v[120:123], v15, s[12:15], s71 offen offset:0 sc1
    buffer_load_dwordx4 v[124:127], v15, s[12:15], s71 offen offset:1024 sc1
    s_lshl_b32 s55, s3, 13
    s_add_u32 s55, s55, 100352
    s_mov_b32 s54, s55
    s_add_u32 s71, s65, 16384
    s_add_u32 m0, s55, 0
    s_nop 0
    buffer_load_dwordx4 v14, s[12:15], s71 offen offset:0 sc1 lds
    buffer_load_dwordx4 v14, s[12:15], s71 offen offset:1024 sc1 lds
    s_add_u32 s71, s65, 20480
    s_add_u32 m0, s55, 2048
    s_nop 0
    buffer_load_dwordx4 v14, s[12:15], s71 offen offset:0 sc1 lds
    buffer_load_dwordx4 v14, s[12:15], s71 offen offset:1024 sc1 lds
    s_add_u32 s71, s65, 24576
    s_add_u32 m0, s55, 4096
    s_nop 0
    buffer_load_dwordx4 v14, s[12:15], s71 offen offset:0 sc1 lds
    buffer_load_dwordx4 v14, s[12:15], s71 offen offset:1024 sc1 lds
    s_add_u32 s71, s65, 0
    s_add_u32 m0, s55, 6144
    s_nop 0
    buffer_load_dwordx4 v15, s[12:15], s71 offen offset:0 sc1 lds
    buffer_load_dwordx4 v15, s[12:15], s71 offen offset:1024 sc1 lds
    s_waitcnt vmcnt(36)
    v_mov_b32 v13, 157952
KC_p1:
    s_setprio 2
    s_mov_b32 s35, 0
.p2align 6
KC_pass:
    ds_read_b128 v[48:51], v7 offset:0
    ds_read_b128 v[52:55], v7 offset:512
    ds_read_b128 v[56:59], v7 offset:2048
    ds_read_b128 v[60:63], v7 offset:2560
    ds_read_b128 v[80:83], v7 offset:4096
    ds_read_b128 v[84:87], v7 offset:4608
    ds_read_b128 v[88:91], v7 offset:6144
    ds_read_b128 v[92:95], v7 offset:6656
    s_waitcnt lgkmcnt(6)
    v_mfma_f32_32x32x16_bf16 v[16:31], v[128:131], v[48:51], 0
    v_mfma_f32_32x32x16_bf16 v[32:47], v[128:131], v[52:55], 0
    ds_read_b128 v[48:51], v7 offset:8192
    ds_read_b128 v[52:55], v7 offset:8704
    s_waitcnt lgkmcnt(6)
    v_mfma_f32_32x32x16_bf16 v[32:47], v[132:135], v[60:63], v[32:47]
    v_mfma_f32_32x32x16_bf16 v[16:31], v[132:135], v[56:59], v[16:31]
    ds_read_b128 v[56:59], v7 offset:10240
    ds_read_b128 v[60:63], v7 offset:10752
    s_waitcnt lgkmcnt(6)
    v_mfma_f32_32x32x16_bf16 v[16:31], v[136:139], v[80:83], v[16:31]
    v_mfma_f32_32x32x16_bf16 v[32:47], v[136:139], v[84:87], v[32:47]
    ds_read_b128 v[80:83], v7 offset:12288
    ds_read_b128 v[84:87], v7 offset:12800
    s_waitcnt lgkmcnt(6)
    v_mfma_f32_32x32x16_bf16 v[32:47], v[140:143], v[92:95], v[32:47]
    v_mfma_f32_32x32x16_bf16 v[16:31], v[140:143], v[88:91], v[16:31]
    ds_read_b128 v[88:91], v7 offset:14336
    ds_read_b128 v[92:95], v7 offset:14848
    s_waitcnt lgkmcnt(6)
    v_mfma_f32_32x32x16_bf16 v[16:31], v[144:147], v[48:51], v[16:31]
    v_mfma_f32_32x32x16_bf16 v[32:47], v[144:147], v[52:55], v[32:47]
    ds_read_b128 v[48:51], v7 offset:16384
    ds_read_b128 v[52:55], v7 offset:16896
    s_waitcnt lgkmcnt(6)
    v_mfma_f32_32x32x16_bf16 v[32:47], v[148:151], v[60:63], v[32:47]
    v_mfma_f32_32x32x16_bf16 v[16:31], v[148:151], v[56:59], v[16:31]
    ds_read_b128 v[56:59], v7 offset:18432
    ds_read_b128 v[60:63], v7 offset:18944
    s_waitcnt lgkmcnt(6)
    v_mfma_f32_32x32x16_bf16 v[16:31], v[152:155], v[80:83], v[16:31]
    v_mfma_f32_32x32x16_bf16 v[32:47], v[152:155], v[84:87], v[32:47]
    ds_read_b128 v[80:83], v7 offset:20480
    ds_read_b128 v[84:87], v7 offset:20992
    s_waitcnt lgkmcnt(6)
    v_mfma_f32_32x32x16_bf16 v[32:47], v[156:159], v[92:95], v[32:47]
    v_mfma_f32_32x32x16_bf16 v[16:31], v[156:159], v[88:91], v[16:31]
    ds_read_b128 v[88:91], v7 offset:22528
    ds_read_b128 v[92:95], v7 offset:23040
    s_waitcnt lgkmcnt(6)
    v_mfma_f32_32x32x16_bf16 v[16:31], v[160:163], v[48:51], v[16:31]
    v_mfma_f32_32x32x16_bf16 v[32:47], v[160:163], v[52:55], v[32:47]
    ds_read_b128 v[48:51], v7 offset:24576
    ds_read_b128 v[52:55], v7 offset:25088
    s_waitcnt lgkmcnt(6)
    v_mfma_f32_32x32x16_bf16 v[32:47], v[164:167], v[60:63], v[32:47]
    v_mfma_f32_32x32x16_bf16 v[16:31], v[164:167], v[56:59], v[16:31]
    ds_read_b128 v[56:59], v7 offset:26624
    ds_read_b128 v[60:63], v7 offset:27136
    s_waitcnt lgkmcnt(6)
    s_cmp_lt_u32 s3, 4
    s_cbranch_scc1 KC_nopk
    s_mov_b64 exec, 1
    s_waitcnt vmcnt(20)
    s_cmp_eq_u32 s35, 0
    s_cbranch_scc1 KC_pk1
    s_waitcnt vmcnt(0)
KC_pk1:
    ds_add_u32 v13, v9
    s_mov_b64 exec, -1
KC_nopk:
    v_mfma_f32_32x32x16_bf16 v[16:31], v[168:171], v[80:83], v[16:31]
    v_mfma_f32_32x32x16_bf16 v[32:47], v[168:171], v[84:87], v[32:47]
    ds_read_b128 v[80:83], v7 offset:28672
    ds_read_b128 v[84:87], v7 offset:29184
    s_waitcnt lgkmcnt(6)
    v_mfma_f32_32x32x16_bf16 v[32:47], v[172:175], v[92:95], v[32:47]
    v_mfma_f32_32x32x16_bf16 v[16:31], v[172:175], v[88:91], v[16:31]
    ds_read_b128 v[88:91], v7 offset:30720
    ds_read_b128 v[92:95], v7 offset:31232
    s_waitcnt lgkmcnt(6)
    v_mfma_f32_32x32x16_bf16 v[16:31], v[176:179], v[48:51], v[16:31]
    v_mfma_f32_32x32x16_bf16 v[32:47], v[176:179], v[52:55], v[32:47]
    ds_read_b128 v[48:51], v7 offset:32768
    ds_read_b128 v[52:55], v7 offset:33280
    s_waitcnt lgkmcnt(6)
    v_mfma_f32_32x32x16_bf16 v[32:47], v[180:183], v[60:63], v[32:47]
    v_mfma_f32_32x32x16_bf16 v[16:31], v[180:183], v[56:59], v[16:31]
    ds_read_b128 v[56:59], v7 offset:34816
    ds_read_b128 v[60:63], v7 offset:35328
    s_waitcnt lgkmcnt(6)
    v_mfma_f32_32x32x16_bf16 v[16:31], v[184:187], v[80:83], v[16:31]
    v_mfma_f32_32x32x16_bf16 v[32:47], v[184:187], v[84:87], v[32:47]
    ds_read_b128 v[80:83], v7 offset:36864
    ds_read_b128 v[84:87], v7 offset:37376
    s_waitcnt lgkmcnt(6)
    v_mfma_f32_32x32x16_bf16 v[32:47], v[188:191], v[92:95], v[32:47]
    v_mfma_f32_32x32x16_bf16 v[16:31], v[188:191], v[88:91], v[16:31]
    ds_read_b128 v[88:91], v7 offset:38912
    ds_read_b128 v[92:95], v7 offset:39424
    s_waitcnt lgkmcnt(6)
    v_mfma_f32_32x32x16_bf16 v[16:31], v[192:195], v[48:51], v[16:31]
    v_mfma_f32_32x32x16_bf16 v[32:47], v[192:195], v[52:55], v[32:47]
    ds_read_b128 v[48:51], v7 offset:40960
    ds_read_b128 v[52:55], v7 offset:41472
    s_waitcnt lgkmcnt(6)
    v_mfma_f32_32x32x16_bf16 v[32:47], v[196:199], v[60:63], v[32:47]
    v_mfma_f32_32x32x16_bf16 v[16:31], v[196:199], v[56:59], v[16:31]
    ds_read_b128 v[56:59], v7 offset:43008
    ds_read_b128 v[60:63], v7 offset:43520
    s_waitcnt lgkmcnt(6)
    ds_read_b32 v12, v10 offset:24
    v_mfma_f32_32x32x16_bf16 v[16:31], v[200:203], v[80:83], v[16:31]
    v_mfma_f32_32x32x16_bf16 v[32:47], v[200:203], v[84:87], v[32:47]
    ds_read_b128 v[80:83], v7 offset:45056
    ds_read_b128 v[84:87], v7 offset:45568
    s_waitcnt lgkmcnt(6)
    v_mfma_f32_32x32x16_bf16 v[32:47], v[204:207], v[92:95], v[32:47]
    v_mfma_f32_32x32x16_bf16 v[16:31], v[204:207], v[88:91], v[16:31]
    ds_read_b128 v[88:91], v7 offset:47104
    ds_read_b128 v[92:95], v7 offset:47616
    s_waitcnt lgkmcnt(6)
    v_mfma_f32_32x32x16_bf16 v[16:31], v[208:211], v[48:51], v[16:31]
    v_mfma_f32_32x32x16_bf16 v[32:47], v[208:211], v[52:55], v[32:47]
    ds_read_b128 v[48:51], v7 offset:49152
    ds_read_b128 v[52:55], v7 offset:49664
    s_waitcnt lgkmcnt(6)
    v_mfma_f32_32x32x16_bf16 v[32:47], v[212:215], v[60:63], v[32:47]
    v_mfma_f32_32x32x16_bf16 v[16:31], v[212:215], v[56:59], v[16:31]
    ds_read_b128 v[56:59], v7 offset:51200
    ds_read_b128 v[60:63], v7 offset:51712
    s_waitcnt lgkmcnt(6)
    s_mov_b32 s44, 0
    s_cmp_lt_u32 s3, 4
    s_cbranch_scc1 KC_noil
    s_cmp_eq_u32 s35, 0
    s_cbranch_scc1 KC_noil
    v_cmp_eq_u32 vcc, 1, v12
    s_cbranch_vccz KC_noil
    s_mov_b32 s44, 1
    s_add_u32 s30, s53, 16384
    buffer_load_dwordx4 v[160:163], v14, s[48:51], s30 offen offset:0 sc1
    buffer_load_dwordx4 v[164:167], v14, s[48:51], s30 offen offset:1024 sc1
    s_add_u32 s30, s53, 20480
    buffer_load_dwordx4 v[168:171], v14, s[48:51], s30 offen offset:0 sc1
    buffer_load_dwordx4 v[172:175], v14, s[48:51], s30 offen offset:1024 sc1
    s_add_u32 s30, s53, 24576
    buffer_load_dwordx4 v[176:179], v14, s[48:51], s30 offen offset:0 sc1
    buffer_load_dwordx4 v[180:183], v14, s[48:51], s30 offen offset:1024 sc1
    s_mov_b32 s52, s23
KC_noil:
    v_mfma_f32_32x32x16_bf16 v[16:31], v[216:219], v[80:83], v[16:31]
    v_mfma_f32_32x32x16_bf16 v[32:47], v[216:219], v[84:87], v[32:47]
    ds_read_b128 v[80:83], v7 offset:53248
    ds_read_b128 v[84:87], v7 offset:53760
    s_waitcnt lgkmcnt(6)
    v_mfma_f32_32x32x16_bf16 v[32:47], v[220:223], v[92:95], v[32:47]
    v_mfma_f32_32x32x16_bf16 v[16:31], v[220:223], v[88:91], v[16:31]
    ds_read_b128 v[88:91], v7 offset:55296
    ds_read_b128 v[92:95], v7 offset:55808
    s_waitcnt lgkmcnt(6)
    v_mfma_f32_32x32x16_bf16 v[16:31], v[224:227], v[48:51], v[16:31]
    v_mfma_f32_32x32x16_bf16 v[32:47], v[224:227], v[52:55], v[32:47]
    ds_read_b128 v[48:51], v7 offset:57344
    ds_read_b128 v[52:55], v7 offset:57856
    s_waitcnt lgkmcnt(6)
    v_mfma_f32_32x32x16_bf16 v[32:47], v[228:231], v[60:63], v[32:47]
    v_mfma_f32_32x32x16_bf16 v[16:31], v[228:231], v[56:59], v[16:31]
    ds_read_b128 v[56:59], v7 offset:59392
    ds_read_b128 v[60:63], v7 offset:59904
    s_waitcnt lgkmcnt(6)
    v_mfma_f32_32x32x16_bf16 v[16:31], v[232:235], v[80:83], v[16:31]
    v_mfma_f32_32x32x16_bf16 v[32:47], v[232:235], v[84:87], v[32:47]
    ds_read_b128 v[80:83], v7 offset:61440
    ds_read_b128 v[84:87], v7 offset:61952
    s_waitcnt lgkmcnt(6)
    v_mfma_f32_32x32x16_bf16 v[32:47], v[236:239], v[92:95], v[32:47]
    v_mfma_f32_32x32x16_bf16 v[16:31], v[236:239], v[88:91], v[16:31]
    ds_read_b128 v[88:91], v7 offset:63488
    ds_read_b128 v[92:95], v7 offset:64000
    s_waitcnt lgkmcnt(0)
    s_cmp_eq_u32 s35, 0
    s_cbranch_scc1 KC_nosr
    s_load_dwordx8 s[36:43], s[56:57], s52 glc
KC_nosr:
    v_mfma_f32_32x32x16_bf16 v[16:31], v[240:243], v[48:51], v[16:31]
    v_mfma_f32_32x32x16_bf16 v[32:47], v[240:243], v[52:55], v[32:47]
    v_mfma_f32_32x32x16_bf16 v[32:47], v[244:247], v[60:63], v[32:47]
    v_mfma_f32_32x32x16_bf16 v[16:31], v[244:247], v[56:59], v[16:31]
    v_mfma_f32_32x32x16_bf16 v[16:31], v[248:251], v[80:83], v[16:31]
    v_mfma_f32_32x32x16_bf16 v[32:47], v[248:251], v[84:87], v[32:47]
    v_mfma_f32_32x32x16_bf16 v[32:47], v[252:255], v[92:95], v[32:47]
    v_mfma_f32_32x32x16_bf16 v[16:31], v[252:255], v[88:91], v[16:31]
    s_setprio 1
    s_cmp_eq_u32 s35, 0
    s_cbranch_scc0 KC_pe2
    s_mov_b64 exec, 1
    s_waitcnt lgkmcnt(0)
    ds_add_u32 v10, v9 offset:4
    s_mov_b64 exec, -1
    s_branch KC_gelu
KC_pe2:
    s_mov_b32 s29, s31
    s_mov_b32 s33, s34
    s_nop 2
KC_gelu:
    s_nop 3
    v_mul_f32 v48, v32, v32
    v_mul_f32 v49, v33, v33
    v_mul_f32 v50, v34, v34
    v_mul_f32 v51, v35, v35
    v_mul_f32 v52, v36, v36
    v_mul_f32 v53, v37, v37
    v_mul_f32 v54, v38, v38
    v_mul_f32 v55, v39, v39
    v_fma_f32 v48, v48, s32, v11
    v_fma_f32 v49, v49, s32, v11
    v_fma_f32 v50, v50, s32, v11
    v_fma_f32 v51, v51, s32, v11
    v_fma_f32 v52, v52, s32, v11
    v_fma_f32 v53, v53, s32, v11
    v_fma_f32 v54, v54, s32, v11
    v_fma_f32 v55, v55, s32, v11
    v_mul_f32 v48, v48, v32
    v_mul_f32 v49, v49, v33
    v_mul_f32 v50, v50, v34
    v_mul_f32 v51, v51, v35
    v_mul_f32 v52, v52, v36
    v_mul_f32 v53, v53, v37
    v_mul_f32 v54, v54, v38
    v_mul_f32 v55, v55, v39
    v_exp_f32 v48, v48
    v_exp_f32 v49, v49
    v_exp_f32 v50, v50
    v_exp_f32 v51, v51
    v_exp_f32 v52, v52
    v_exp_f32 v53, v53
    v_exp_f32 v54, v54
    v_exp_f32 v55, v55
    v_mul_f32 v40, v40, v32
    v_mul_f32 v41, v41, v33
    v_mul_f32 v42, v42, v34
    v_mul_f32 v43, v43, v35
    v_mul_f32 v44, v44, v36
    v_mul_f32 v45, v45, v37
    v_mul_f32 v46, v46, v38
    v_mul_f32 v47, v47, v39
    v_add_f32 v48, 1.0, v48
    v_add_f32 v49, 1.0, v49
    v_add_f32 v50, 1.0, v50
    v_add_f32 v51, 1.0, v51
    v_add_f32 v52, 1.0, v52
    v_add_f32 v53, 1.0, v53
    v_add_f32 v54, 1.0, v54
    v_add_f32 v55, 1.0, v55
    v_rcp_f32 v48, v48
    v_rcp_f32 v49, v49
    v_rcp_f32 v50, v50
    v_rcp_f32 v51, v51
    v_rcp_f32 v52, v52
    v_rcp_f32 v53, v53
    v_rcp_f32 v54, v54
    v_rcp_f32 v55, v55
    v_mul_f32 v40, v40, v48
    v_mul_f32 v41, v41, v49
    v_mul_f32 v42, v42, v50
    v_mul_f32 v43, v43, v51
    v_mul_f32 v44, v44, v52
    v_mul_f32 v45, v45, v53
    v_mul_f32 v46, v46, v54
    v_mul_f32 v47, v47, v55
    v_cvt_pk_bf16_f32 v32, v40, v41
    v_cvt_pk_bf16_f32 v33, v42, v43
    v_cvt_pk_bf16_f32 v34, v44, v45
    v_cvt_pk_bf16_f32 v35, v46, v47
    buffer_store_dwordx4 v[32:35], v5, s[48:51], s29 offen offset:1024 sc1
    v_mul_f32 v48, v16, v16
    v_mul_f32 v49, v17, v17
    v_mul_f32 v50, v18, v18
    v_mul_f32 v51, v19, v19
    v_mul_f32 v52, v20, v20
    v_mul_f32 v53, v21, v21
    v_mul_f32 v54, v22, v22
    v_mul_f32 v55, v23, v23
    v_fma_f32 v48, v48, s32, v11
    v_fma_f32 v49, v49, s32, v11
    v_fma_f32 v50, v50, s32, v11
    v_fma_f32 v51, v51, s32, v11
    v_fma_f32 v52, v52, s32, v11
    v_fma_f32 v53, v53, s32, v11
    v_fma_f32 v54, v54, s32, v11
    v_fma_f32 v55, v55, s32, v11
    v_mul_f32 v48, v48, v16
    v_mul_f32 v49, v49, v17
    v_mul_f32 v50, v50, v18
    v_mul_f32 v51, v51, v19
    v_mul_f32 v52, v52, v20
    v_mul_f32 v53, v53, v21
    v_mul_f32 v54, v54, v22
    v_mul_f32 v55, v55, v23
    v_exp_f32 v48, v48
    v_exp_f32 v49, v49
    v_exp_f32 v50, v50
    v_exp_f32 v51, v51
    v_exp_f32 v52, v52
    v_exp_f32 v53, v53
    v_exp_f32 v54, v54
    v_exp_f32 v55, v55
    v_mul_f32 v24, v24, v16
    v_mul_f32 v25, v25, v17
    v_mul_f32 v26, v26, v18
    v_mul_f32 v27, v27, v19
    v_mul_f32 v28, v28, v20
    v_mul_f32 v29, v29, v21
    v_mul_f32 v30, v30, v22
    v_mul_f32 v31, v31, v23
    v_add_f32 v48, 1.0, v48
    v_add_f32 v49, 1.0, v49
    v_add_f32 v50, 1.0, v50
    v_add_f32 v51, 1.0, v51
    v_add_f32 v52, 1.0, v52
    v_add_f32 v53, 1.0, v53
    v_add_f32 v54, 1.0, v54
    v_add_f32 v55, 1.0, v55
    v_rcp_f32 v48, v48
    v_rcp_f32 v49, v49
    v_rcp_f32 v50, v50
    v_rcp_f32 v51, v51
    v_rcp_f32 v52, v52
    v_rcp_f32 v53, v53
    v_rcp_f32 v54, v54
    v_rcp_f32 v55, v55
    v_mul_f32 v24, v24, v48
    v_mul_f32 v25, v25, v49
    v_mul_f32 v26, v26, v50
    v_mul_f32 v27, v27, v51
    v_mul_f32 v28, v28, v52
    v_mul_f32 v29, v29, v53
    v_mul_f32 v30, v30, v54
    v_mul_f32 v31, v31, v55
    v_cvt_pk_bf16_f32 v16, v24, v25
    v_cvt_pk_bf16_f32 v17, v26, v27
    v_cvt_pk_bf16_f32 v18, v28, v29
    v_cvt_pk_bf16_f32 v19, v30, v31
    buffer_store_dwordx4 v[16:19], v5, s[48:51], s29 offen offset:0 sc1
    s_cmp_eq_u32 s35, 0
    s_cbranch_scc0 KC_after2
    s_mov_b32 s35, 1
    v_add_u32 v7, 0x10000, v7
    s_cmp_lt_u32 s3, 4
    s_cbranch_scc0 KC_mid_hi
    s_mov_b64 exec, 1
    s_waitcnt vmcnt(0)
    buffer_store_dword v9, v8, s[8:11], s33 offen sc1
    s_mov_b64 exec, -1
    s_add_u32 s71, s65, 4096
    buffer_load_dwordx4 v[64:67], v15, s[12:15], s71 offen offset:0 sc1
    buffer_load_dwordx4 v[68:71], v15, s[12:15], s71 offen offset:1024 sc1
    s_add_u32 s71, s65, 8192
    buffer_load_dwordx4 v[72:75], v15, s[12:15], s71 offen offset:0 sc1
    buffer_load_dwordx4 v[76:79], v15, s[12:15], s71 offen offset:1024 sc1
    s_add_u32 s71, s65, 12288
    buffer_load_dwordx4 v[96:99], v15, s[12:15], s71 offen offset:0 sc1
    buffer_load_dwordx4 v[100:103], v15, s[12:15], s71 offen offset:1024 sc1
    s_add_u32 s71, s65, 16384
    buffer_load_dwordx4 v[104:107], v15, s[12:15], s71 offen offset:0 sc1
    buffer_load_dwordx4 v[108:111], v15, s[12:15], s71 offen offset:1024 sc1
    s_add_u32 s71, s65, 20480
    buffer_load_dwordx4 v[112:115], v15, s[12:15], s71 offen offset:0 sc1
    buffer_load_dwordx4 v[116:119], v15, s[12:15], s71 offen offset:1024 sc1
    s_add_u32 s71, s65, 24576
    buffer_load_dwordx4 v[120:123], v15, s[12:15], s71 offen offset:0 sc1
    buffer_load_dwordx4 v[124:127], v15, s[12:15], s71 offen offset:1024 sc1
    s_branch KC_mid_done
KC_mid_hi:
    s_mov_b64 exec, 1
    s_waitcnt vmcnt(0)
    buffer_store_dword v9, v8, s[8:11], s33 offen sc1
    s_mov_b64 exec, -1
    s_mov_b32 s47, 30000
KC_lsa2906:
    ds_read_b32 v12, v10 offset:4
    s_sub_u32 s47, s47, 1
    s_cbranch_scc1 KC_lga2906
    s_waitcnt lgkmcnt(0)
    v_cmp_le_u32 vcc, 7, v12
    s_cbranch_vccnz KC_lga2906
    s_sleep 1
    s_branch KC_lsa2906
KC_lga2906:
    s_and_b32 s55, s3, 3
    s_lshl_b32 s55, s55, 14
    s_xor_b32 s26, s70, 4
    s_sub_u32 s26, s26, s70
    s_mul_i32 s26, s26, 229376
    s_add_u32 s26, s26, s65
    s_add_u32 s71, s26, 0
    s_add_u32 m0, s55, 0
    s_nop 0
    buffer_load_dwordx4 v14, s[12:15], s71 offen offset:0 sc1 lds
    buffer_load_dwordx4 v14, s[12:15], s71 offen offset:1024 sc1 lds
    s_add_u32 s71, s26, 4096
    s_add_u32 m0, s55, 2048
    s_nop 0
    buffer_load_dwordx4 v14, s[12:15], s71 offen offset:0 sc1 lds
    buffer_load_dwordx4 v14, s[12:15], s71 offen offset:1024 sc1 lds
    s_add_u32 s71, s26, 8192
    s_add_u32 m0, s55, 4096
    s_nop 0
    buffer_load_dwordx4 v14, s[12:15], s71 offen offset:0 sc1 lds
    buffer_load_dwordx4 v14, s[12:15], s71 offen offset:1024 sc1 lds
    s_add_u32 s71, s26, 12288
    s_add_u32 m0, s55, 6144
    s_nop 0
    buffer_load_dwordx4 v14, s[12:15], s71 offen offset:0 sc1 lds
    buffer_load_dwordx4 v14, s[12:15], s71 offen offset:1024 sc1 lds
    s_add_u32 s71, s26, 16384
    s_add_u32 m0, s55, 8192
    s_nop 0
    buffer_load_dwordx4 v14, s[12:15], s71 offen offset:0 sc1 lds
    buffer_load_dwordx4 v14, s[12:15], s71 offen offset:1024 sc1 lds
    s_add_u32 s71, s26, 20480
    s_add_u32 m0, s55, 10240
    s_nop 0
    buffer_load_dwordx4 v14, s[12:15], s71 offen offset:0 sc1 lds
    buffer_load_dwordx4 v14, s[12:15], s71 offen offset:1024 sc1 lds
    s_add_u32 s71, s26, 24576
    s_add_u32 m0, s55, 12288
    s_nop 0
    buffer_load_dwordx4 v14, s[12:15], s71 offen offset:0 sc1 lds
    buffer_load_dwordx4 v14, s[12:15], s71 offen offset:1024 sc1 lds
    s_add_u32 s71, s26, 0
    s_add_u32 m0, s55, 14336
    s_nop 0
    buffer_load_dwordx4 v15, s[12:15], s71 offen offset:0 sc1 lds
    buffer_load_dwordx4 v15, s[12:15], s71 offen offset:1024 sc1 lds
    v_mov_b32 v13, 157964
KC_mid_done:
    s_mov_b32 s47, 30000
KC_lsb:
    ds_read_b32 v12, v10 offset:0
    s_sub_u32 s47, s47, 1
    s_cbranch_scc1 KC_lgb
    s_waitcnt lgkmcnt(0)
    v_cmp_le_u32 vcc, 4, v12
    s_cbranch_vccnz KC_lgb
    s_sleep 1
    s_branch KC_lsb
KC_lgb:
    s_branch KC_pass
KC_after2:
    s_mov_b64 exec, 1
    s_waitcnt lgkmcnt(0)
    ds_add_u32 v10, v9 offset:8
    s_mov_b64 exec, -1
    s_cmp_lt_u32 s3, 4
    s_cbranch_scc1 KC_lo2
    v_add_u32 v13, s54, v5
    ds_read_b128 v[48:51], v13 offset:0
    ds_read_b128 v[52:55], v13 offset:1024
    ds_read_b128 v[56:59], v13 offset:2048
    ds_read_b128 v[60:63], v13 offset:3072
    ds_read_b128 v[88:91], v13 offset:4096
    ds_read_b128 v[92:95], v13 offset:5120
    ds_read_b128 v[80:83], v13 offset:6144
    ds_read_b128 v[84:87], v13 offset:7168
    s_cmp_eq_u32 s44, 1
    s_cbranch_scc0 KC_i4s
    s_and_b32 s28, s36, s37
    s_and_b32 s28, s28, s38
    s_and_b32 s28, s28, s39
    s_cmp_eq_u32 s28, 1
    s_cbranch_scc0 KC_i4t
    s_add_u32 s30, s53, 0
    buffer_load_dwordx4 v[128:131], v15, s[48:51], s30 offen offset:0 sc1
    buffer_load_dwordx4 v[132:135], v15, s[48:51], s30 offen offset:1024 sc1
    s_add_u32 s30, s53, 4096
    buffer_load_dwordx4 v[136:139], v15, s[48:51], s30 offen offset:0 sc1
    buffer_load_dwordx4 v[140:143], v15, s[48:51], s30 offen offset:1024 sc1
    s_add_u32 s30, s53, 8192
    buffer_load_dwordx4 v[144:147], v15, s[48:51], s30 offen offset:0 sc1
    buffer_load_dwordx4 v[148:151], v15, s[48:51], s30 offen offset:1024 sc1
    s_add_u32 s30, s53, 12288
    buffer_load_dwordx4 v[152:155], v15, s[48:51], s30 offen offset:0 sc1
    buffer_load_dwordx4 v[156:159], v15, s[48:51], s30 offen offset:1024 sc1
    s_waitcnt vmcnt(10) lgkmcnt(0)
    v_mfma_f32_32x32x16_bf16 v[192:207], v[48:51], v[160:163], 0
    v_mfma_f32_32x32x16_bf16 v[208:223], v[48:51], v[164:167], 0
    v_mfma_f32_32x32x16_bf16 v[240:255], v[52:55], v[164:167], 0
    v_mfma_f32_32x32x16_bf16 v[224:239], v[52:55], v[160:163], 0
    s_mov_b64 exec, 1
    s_waitcnt vmcnt(8)
    buffer_store_dword v9, v8, s[8:11], s33 offen sc1
    s_mov_b64 exec, -1
    s_setprio 1
    v_mfma_f32_32x32x16_bf16 v[192:207], v[56:59], v[168:171], v[192:207]
    v_mfma_f32_32x32x16_bf16 v[208:223], v[56:59], v[172:175], v[208:223]
    v_mfma_f32_32x32x16_bf16 v[240:255], v[60:63], v[172:175], v[240:255]
    v_mfma_f32_32x32x16_bf16 v[224:239], v[60:63], v[168:171], v[224:239]
    v_mfma_f32_32x32x16_bf16 v[192:207], v[88:91], v[176:179], v[192:207]
    v_mfma_f32_32x32x16_bf16 v[208:223], v[88:91], v[180:183], v[208:223]
    v_mfma_f32_32x32x16_bf16 v[240:255], v[92:95], v[180:183], v[240:255]
    v_mfma_f32_32x32x16_bf16 v[224:239], v[92:95], v[176:179], v[224:239]
    s_branch KC_b2
KC_i4t:
    s_waitcnt vmcnt(2) lgkmcnt(0)
    v_mfma_f32_32x32x16_bf16 v[192:207], v[48:51], v[160:163], 0
    v_mfma_f32_32x32x16_bf16 v[208:223], v[48:51], v[164:167], 0
    v_mfma_f32_32x32x16_bf16 v[240:255], v[52:55], v[164:167], 0
    v_mfma_f32_32x32x16_bf16 v[224:239], v[52:55], v[160:163], 0
    s_mov_b64 exec, 1
    s_waitcnt vmcnt(0)
    buffer_store_dword v9, v8, s[8:11], s33 offen sc1
    s_mov_b64 exec, -1
    s_setprio 1
    v_mfma_f32_32x32x16_bf16 v[192:207], v[56:59], v[168:171], v[192:207]
    v_mfma_f32_32x32x16_bf16 v[208:223], v[56:59], v[172:175], v[208:223]
    v_mfma_f32_32x32x16_bf16 v[240:255], v[60:63], v[172:175], v[240:255]
    v_mfma_f32_32x32x16_bf16 v[224:239], v[60:63], v[168:171], v[224:239]
    v_mfma_f32_32x32x16_bf16 v[192:207], v[88:91], v[176:179], v[192:207]
    v_mfma_f32_32x32x16_bf16 v[208:223], v[88:91], v[180:183], v[208:223]
    v_mfma_f32_32x32x16_bf16 v[240:255], v[92:95], v[180:183], v[240:255]
    v_mfma_f32_32x32x16_bf16 v[224:239], v[92:95], v[176:179], v[224:239]
    s_branch KC_slow3
KC_i4s:
    v_mov_b32 v192, 0
    v_mov_b32 v193, 0
    v_mov_b32 v194, 0
    v_mov_b32 v195, 0
    v_mov_b32 v196, 0
    v_mov_b32 v197, 0
    v_mov_b32 v198, 0
    v_mov_b32 v199, 0
    v_mov_b32 v200, 0
    v_mov_b32 v201, 0
    v_mov_b32 v202, 0
    v_mov_b32 v203, 0
    v_mov_b32 v204, 0
    v_mov_b32 v205, 0
    v_mov_b32 v206, 0
    v_mov_b32 v207, 0
    v_mov_b32 v208, 0
    v_mov_b32 v209, 0
    v_mov_b32 v210, 0
    v_mov_b32 v211, 0
    v_mov_b32 v212, 0
    v_mov_b32 v213, 0
    v_mov_b32 v214, 0
    v_mov_b32 v215, 0
    v_mov_b32 v216, 0
    v_mov_b32 v217, 0
    v_mov_b32 v218, 0
    v_mov_b32 v219, 0
    v_mov_b32 v220, 0
    v_mov_b32 v221, 0
    v_mov_b32 v222, 0
    v_mov_b32 v223, 0
    v_mov_b32 v224, 0
    v_mov_b32 v225, 0
    v_mov_b32 v226, 0
    v_mov_b32 v227, 0
    v_mov_b32 v228, 0
    v_mov_b32 v229, 0
    v_mov_b32 v230, 0
    v_mov_b32 v231, 0
    v_mov_b32 v232, 0
    v_mov_b32 v233, 0
    v_mov_b32 v234, 0
    v_mov_b32 v235, 0
    v_mov_b32 v236, 0
    v_mov_b32 v237, 0
    v_mov_b32 v238, 0
    v_mov_b32 v239, 0
    v_mov_b32 v240, 0
    v_mov_b32 v241, 0
    v_mov_b32 v242, 0
    v_mov_b32 v243, 0
    v_mov_b32 v244, 0
    v_mov_b32 v245, 0
    v_mov_b32 v246, 0
    v_mov_b32 v247, 0
    v_mov_b32 v248, 0
    v_mov_b32 v249, 0
    v_mov_b32 v250, 0
    v_mov_b32 v251, 0
    v_mov_b32 v252, 0
    v_mov_b32 v253, 0
    v_mov_b32 v254, 0
    v_mov_b32 v255, 0
    s_mov_b64 exec, 1
    s_waitcnt vmcnt(0)
    buffer_store_dword v9, v8, s[8:11], s33 offen sc1
    s_mov_b64 exec, -1
    s_mov_b32 s47, 30000
KC_pli4:
    s_load_dwordx8 s[36:43], s[56:57], s52 glc
    s_waitcnt lgkmcnt(0)
    s_and_b32 s28, s40, s41
    s_and_b32 s28, s28, s42
    s_cmp_eq_u32 s28, 1
    s_cbranch_scc1 KC_gti4
    s_sleep 4
    s_sub_u32 s47, s47, 1
    s_cbranch_scc0 KC_pli4
KC_gti4:
    s_add_u32 s30, s53, 16384
    buffer_load_dwordx4 v[160:163], v14, s[48:51], s30 offen offset:0 sc1
    buffer_load_dwordx4 v[164:167], v14, s[48:51], s30 offen offset:1024 sc1
    s_add_u32 s30, s53, 20480
    buffer_load_dwordx4 v[168:171], v14, s[48:51], s30 offen offset:0 sc1
    buffer_load_dwordx4 v[172:175], v14, s[48:51], s30 offen offset:1024 sc1
    s_add_u32 s30, s53, 24576
    buffer_load_dwordx4 v[176:179], v14, s[48:51], s30 offen offset:0 sc1
    buffer_load_dwordx4 v[180:183], v14, s[48:51], s30 offen offset:1024 sc1
    s_load_dwordx8 s[36:43], s[56:57], s23 glc
    s_setprio 1
    s_branch KC_hj
KC_w7b:
    s_setprio 3
    s_add_u32 s71, s65, 4096
    buffer_load_dwordx4 v[64:67], v15, s[12:15], s71 offen offset:0 sc1
    buffer_load_dwordx4 v[68:71], v15, s[12:15], s71 offen offset:1024 sc1
    s_add_u32 s71, s65, 8192
    buffer_load_dwordx4 v[72:75], v15, s[12:15], s71 offen offset:0 sc1
    buffer_load_dwordx4 v[76:79], v15, s[12:15], s71 offen offset:1024 sc1
    s_add_u32 s71, s65, 12288
    buffer_load_dwordx4 v[96:99], v15, s[12:15], s71 offen offset:0 sc1
    buffer_load_dwordx4 v[100:103], v15, s[12:15], s71 offen offset:1024 sc1
    s_add_u32 s71, s65, 16384
    buffer_load_dwordx4 v[104:107], v15, s[12:15], s71 offen offset:0 sc1
    buffer_load_dwordx4 v[108:111], v15, s[12:15], s71 offen offset:1024 sc1
    s_add_u32 s71, s65, 20480
    buffer_load_dwordx4 v[112:115], v15, s[12:15], s71 offen offset:0 sc1
    buffer_load_dwordx4 v[116:119], v15, s[12:15], s71 offen offset:1024 sc1
    s_add_u32 s71, s65, 24576
    buffer_load_dwordx4 v[120:123], v15, s[12:15], s71 offen offset:0 sc1
    buffer_load_dwordx4 v[124:127], v15, s[12:15], s71 offen offset:1024 sc1
    s_waitcnt vmcnt(12)
    s_mov_b64 exec, 1
    s_waitcnt lgkmcnt(0)
    ds_add_u32 v10, v9 offset:0
    s_mov_b64 exec, -1
    s_add_u32 s71, s65, 0
    buffer_load_dwordx4 v[80:83], v15, s[12:15], s71 offen offset:0 sc1
    buffer_load_dwordx4 v[84:87], v15, s[12:15], s71 offen offset:1024 sc1
    s_add_u32 s44, s70, 5
    s_and_b32 s44, s44, 7
    s_sub_u32 s44, s44, s70
    s_add_u32 s45, s70, 6
    s_and_b32 s45, s45, 7
    s_sub_u32 s45, s45, s70
    s_add_u32 s46, s70, 7
    s_and_b32 s46, s46, 7
    s_sub_u32 s46, s46, s70
    s_add_u32 s54, s70, 8
    s_and_b32 s54, s54, 7
    s_sub_u32 s54, s54, s70
    s_mul_i32 s71, s44, 229376
    s_add_u32 s71, s71, s65
    s_add_u32 s71, s71, 0
    buffer_load_dwordx4 v[16:19], v14, s[12:15], s71 offen offset:0 sc1
    buffer_load_dwordx4 v[20:23], v14, s[12:15], s71 offen offset:1024 sc1
    s_mul_i32 s71, s44, 229376
    s_add_u32 s71, s71, s65
    s_add_u32 s71, s71, 4096
    buffer_load_dwordx4 v[32:35], v14, s[12:15], s71 offen offset:0 sc1
    buffer_load_dwordx4 v[36:39], v14, s[12:15], s71 offen offset:1024 sc1
    s_mul_i32 s71, s44, 229376
    s_add_u32 s71, s71, s65
    s_add_u32 s71, s71, 8192
    buffer_load_dwordx4 v[48:51], v14, s[12:15], s71 offen offset:0 sc1
    buffer_load_dwordx4 v[52:55], v14, s[12:15], s71 offen offset:1024 sc1
    s_mul_i32 s71, s44, 229376
    s_add_u32 s71, s71, s65
    s_add_u32 s71, s71, 12288
    buffer_load_dwordx4 v[128:131], v14, s[12:15], s71 offen offset:0 sc1
    buffer_load_dwordx4 v[132:135], v14, s[12:15], s71 offen offset:1024 sc1
    s_mul_i32 s71, s45, 229376
    s_add_u32 s71, s71, s65
    s_add_u32 s71, s71, 0
    buffer_load_dwordx4 v[144:147], v14, s[12:15], s71 offen offset:0 sc1
    buffer_load_dwordx4 v[148:151], v14, s[12:15], s71 offen offset:1024 sc1
    s_mul_i32 s71, s45, 229376
    s_add_u32 s71, s71, s65
    s_add_u32 s71, s71, 4096
    buffer_load_dwordx4 v[160:163], v14, s[12:15], s71 offen offset:0 sc1
    buffer_load_dwordx4 v[164:167], v14, s[12:15], s71 offen offset:1024 sc1
    s_mul_i32 s71, s45, 229376
    s_add_u32 s71, s71, s65
    s_add_u32 s71, s71, 8192
    buffer_load_dwordx4 v[176:179], v14, s[12:15], s71 offen offset:0 sc1
    buffer_load_dwordx4 v[180:183], v14, s[12:15], s71 offen offset:1024 sc1
    s_mov_b32 s47, 30000
KC_q0:
    s_lshl_b32 s34, s44, 7
    s_add_u32 s34, s34, s52
    s_add_u32 s34, s34, 0
    s_load_dwordx4 s[36:39], s[56:57], s34 glc
    s_lshl_b32 s34, s45, 7
    s_add_u32 s34, s34, s52
    s_add_u32 s34, s34, 0
    s_load_dwordx4 s[40:43], s[56:57], s34 glc
    s_lshl_b32 s34, s46, 7
    s_add_u32 s34, s34, s52
    s_add_u32 s34, s34, 0
    s_load_dwordx4 s[24:27], s[56:57], s34 glc
    s_lshl_b32 s34, s54, 7
    s_add_u32 s34, s34, s52
    s_add_u32 s34, s34, 0
    s_load_dwordx4 s[28:31], s[56:57], s34 glc
    s_waitcnt lgkmcnt(0)
    s_and_b64 s[36:37], s[36:37], s[40:41]
    s_and_b64 s[38:39], s[38:39], s[42:43]
    s_and_b64 s[36:37], s[36:37], s[24:25]
    s_and_b64 s[38:39], s[38:39], s[26:27]
    s_and_b64 s[36:37], s[36:37], s[28:29]
    s_and_b64 s[38:39], s[38:39], s[30:31]
    s_and_b32 s36, s36, s37
    s_and_b32 s36, s36, s38
    s_and_b32 s36, s36, s39
    s_cmp_eq_u32 s36, 1
    s_cbranch_scc1 KC_r0
    s_sleep 4
    s_sub_u32 s47, s47, 1
    s_cbranch_scc0 KC_q0
KC_r0:
    s_mul_i32 s33, s44, 28672
    s_add_u32 s33, s33, s53
    s_add_u32 s33, s33, 0
    buffer_load_dwordx4 v[24:27], v14, s[48:51], s33 offen offset:0 sc1
    buffer_load_dwordx4 v[28:31], v14, s[48:51], s33 offen offset:1024 sc1
    s_mul_i32 s33, s44, 28672
    s_add_u32 s33, s33, s53
    s_add_u32 s33, s33, 4096
    buffer_load_dwordx4 v[40:43], v14, s[48:51], s33 offen offset:0 sc1
    buffer_load_dwordx4 v[44:47], v14, s[48:51], s33 offen offset:1024 sc1
    s_mul_i32 s33, s44, 28672
    s_add_u32 s33, s33, s53
    s_add_u32 s33, s33, 8192
    buffer_load_dwordx4 v[56:59], v14, s[48:51], s33 offen offset:0 sc1
    buffer_load_dwordx4 v[60:63], v14, s[48:51], s33 offen offset:1024 sc1
    s_mul_i32 s33, s44, 28672
    s_add_u32 s33, s33, s53
    s_add_u32 s33, s33, 12288
    buffer_load_dwordx4 v[136:139], v14, s[48:51], s33 offen offset:0 sc1
    buffer_load_dwordx4 v[140:143], v14, s[48:51], s33 offen offset:1024 sc1
    s_mul_i32 s33, s45, 28672
    s_add_u32 s33, s33, s53
    s_add_u32 s33, s33, 0
    buffer_load_dwordx4 v[152:155], v14, s[48:51], s33 offen offset:0 sc1
    buffer_load_dwordx4 v[156:159], v14, s[48:51], s33 offen offset:1024 sc1
    s_mul_i32 s33, s45, 28672
    s_add_u32 s33, s33, s53
    s_add_u32 s33, s33, 4096
    buffer_load_dwordx4 v[168:171], v14, s[48:51], s33 offen offset:0 sc1
    buffer_load_dwordx4 v[172:175], v14, s[48:51], s33 offen offset:1024 sc1
    s_mul_i32 s33, s45, 28672
    s_add_u32 s33, s33, s53
    s_add_u32 s33, s33, 8192
    buffer_load_dwordx4 v[184:187], v14, s[48:51], s33 offen offset:0 sc1
    buffer_load_dwordx4 v[188:191], v14, s[48:51], s33 offen offset:1024 sc1
    s_mov_b32 s47, 30000
KC_lsa3280:
    ds_read_b32 v12, v10 offset:4
    s_sub_u32 s47, s47, 1
    s_cbranch_scc1 KC_lga3280
    s_waitcnt lgkmcnt(0)
    v_cmp_le_u32 vcc, 7, v12
    s_cbranch_vccnz KC_lga3280
    s_sleep 1
    s_branch KC_lsa3280
KC_lga3280:
    s_and_b32 s55, s3, 3
    s_lshl_b32 s55, s55, 14
    s_xor_b32 s26, s70, 4
    s_sub_u32 s26, s26, s70
    s_mul_i32 s26, s26, 229376
    s_add_u32 s26, s26, s65
    s_add_u32 s71, s26, 0
    s_add_u32 m0, s55, 0
    s_nop 0
    buffer_load_dwordx4 v14, s[12:15], s71 offen offset:0 sc1 lds
    buffer_load_dwordx4 v14, s[12:15], s71 offen offset:1024 sc1 lds
    s_add_u32 s71, s26, 4096
    s_add_u32 m0, s55, 2048
    s_nop 0
    buffer_load_dwordx4 v14, s[12:15], s71 offen offset:0 sc1 lds
    buffer_load_dwordx4 v14, s[12:15], s71 offen offset:1024 sc1 lds
    s_add_u32 s71, s26, 8192
    s_add_u32 m0, s55, 4096
    s_nop 0
    buffer_load_dwordx4 v14, s[12:15], s71 offen offset:0 sc1 lds
    buffer_load_dwordx4 v14, s[12:15], s71 offen offset:1024 sc1 lds
    s_add_u32 s71, s26, 12288
    s_add_u32 m0, s55, 6144
    s_nop 0
    buffer_load_dwordx4 v14, s[12:15], s71 offen offset:0 sc1 lds
    buffer_load_dwordx4 v14, s[12:15], s71 offen offset:1024 sc1 lds
    s_add_u32 s71, s26, 16384
    s_add_u32 m0, s55, 8192
    s_nop 0
    buffer_load_dwordx4 v14, s[12:15], s71 offen offset:0 sc1 lds
    buffer_load_dwordx4 v14, s[12:15], s71 offen offset:1024 sc1 lds
    s_add_u32 s71, s26, 20480
    s_add_u32 m0, s55, 10240
    s_nop 0
    buffer_load_dwordx4 v14, s[12:15], s71 offen offset:0 sc1 lds
    buffer_load_dwordx4 v14, s[12:15], s71 offen offset:1024 sc1 lds
    s_add_u32 s71, s26, 24576
    s_add_u32 m0, s55, 12288
    s_nop 0
    buffer_load_dwordx4 v14, s[12:15], s71 offen offset:0 sc1 lds
    buffer_load_dwordx4 v14, s[12:15], s71 offen offset:1024 sc1 lds
    s_add_u32 s71, s26, 0
    s_add_u32 m0, s55, 14336
    s_nop 0
    buffer_load_dwordx4 v15, s[12:15], s71 offen offset:0 sc1 lds
    buffer_load_dwordx4 v15, s[12:15], s71 offen offset:1024 sc1 lds
    s_waitcnt vmcnt(28)
    v_mfma_f32_32x32x16_bf16 v[192:207], v[16:19], v[24:27], 0
    v_mfma_f32_32x32x16_bf16 v[208:223], v[16:19], v[28:31], 0
    v_mfma_f32_32x32x16_bf16 v[240:255], v[20:23], v[28:31], 0
    v_mfma_f32_32x32x16_bf16 v[224:239], v[20:23], v[24:27], 0
    s_mul_i32 s71, s45, 229376
    s_add_u32 s71, s71, s65
    s_add_u32 s71, s71, 12288
    buffer_load_dwordx4 v[16:19], v14, s[12:15], s71 offen offset:0 sc1
    buffer_load_dwordx4 v[20:23], v14, s[12:15], s71 offen offset:1024 sc1
    s_mul_i32 s33, s45, 28672
    s_add_u32 s33, s33, s53
    s_add_u32 s33, s33, 12288
    buffer_load_dwordx4 v[24:27], v14, s[48:51], s33 offen offset:0 sc1
    buffer_load_dwordx4 v[28:31], v14, s[48:51], s33 offen offset:1024 sc1
    s_waitcnt vmcnt(30)
    v_mfma_f32_32x32x16_bf16 v[192:207], v[32:35], v[40:43], v[192:207]
    v_mfma_f32_32x32x16_bf16 v[208:223], v[32:35], v[44:47], v[208:223]
    v_mfma_f32_32x32x16_bf16 v[240:255], v[36:39], v[44:47], v[240:255]
    v_mfma_f32_32x32x16_bf16 v[224:239], v[36:39], v[40:43], v[224:239]
    s_mul_i32 s71, s46, 229376
    s_add_u32 s71, s71, s65
    s_add_u32 s71, s71, 0
    buffer_load_dwordx4 v[32:35], v14, s[12:15], s71 offen offset:0 sc1
    buffer_load_dwordx4 v[36:39], v14, s[12:15], s71 offen offset:1024 sc1
    s_mul_i32 s33, s46, 28672
    s_add_u32 s33, s33, s53
    s_add_u32 s33, s33, 0
    buffer_load_dwordx4 v[40:43], v14, s[48:51], s33 offen offset:0 sc1
    buffer_load_dwordx4 v[44:47], v14, s[48:51], s33 offen offset:1024 sc1
    s_waitcnt vmcnt(32)
    v_mfma_f32_32x32x16_bf16 v[192:207], v[48:51], v[56:59], v[192:207]
    v_mfma_f32_32x32x16_bf16 v[208:223], v[48:51], v[60:63], v[208:223]
    v_mfma_f32_32x32x16_bf16 v[240:255], v[52:55], v[60:63], v[240:255]
    v_mfma_f32_32x32x16_bf16 v[224:239], v[52:55], v[56:59], v[224:239]
    s_mul_i32 s71, s46, 229376
    s_add_u32 s71, s71, s65
    s_add_u32 s71, s71, 4096
    buffer_load_dwordx4 v[48:51], v14, s[12:15], s71 offen offset:0 sc1
    buffer_load_dwordx4 v[52:55], v14, s[12:15], s71 offen offset:1024 sc1
    s_mul_i32 s33, s46, 28672
    s_add_u32 s33, s33, s53
    s_add_u32 s33, s33, 4096
    buffer_load_dwordx4 v[56:59], v14, s[48:51], s33 offen offset:0 sc1
    buffer_load_dwordx4 v[60:63], v14, s[48:51], s33 offen offset:1024 sc1
    s_waitcnt vmcnt(34)
    v_mfma_f32_32x32x16_bf16 v[192:207], v[128:131], v[136:139], v[192:207]
    v_mfma_f32_32x32x16_bf16 v[208:223], v[128:131], v[140:143], v[208:223]
    v_mfma_f32_32x32x16_bf16 v[240:255], v[132:135], v[140:143], v[240:255]
    v_mfma_f32_32x32x16_bf16 v[224:239], v[132:135], v[136:139], v[224:239]
    s_mul_i32 s71, s46, 229376
    s_add_u32 s71, s71, s65
    s_add_u32 s71, s71, 8192
    buffer_load_dwordx4 v[128:131], v14, s[12:15], s71 offen offset:0 sc1
    buffer_load_dwordx4 v[132:135], v14, s[12:15], s71 offen offset:1024 sc1
    s_mul_i32 s33, s46, 28672
    s_add_u32 s33, s33, s53
    s_add_u32 s33, s33, 8192
    buffer_load_dwordx4 v[136:139], v14, s[48:51], s33 offen offset:0 sc1
    buffer_load_dwordx4 v[140:143], v14, s[48:51], s33 offen offset:1024 sc1
    s_waitcnt vmcnt(36)
    v_mfma_f32_32x32x16_bf16 v[192:207], v[144:147], v[152:155], v[192:207]
    v_mfma_f32_32x32x16_bf16 v[208:223], v[144:147], v[156:159], v[208:223]
    v_mfma_f32_32x32x16_bf16 v[240:255], v[148:151], v[156:159], v[240:255]
    v_mfma_f32_32x32x16_bf16 v[224:239], v[148:151], v[152:155], v[224:239]
    s_mul_i32 s71, s46, 229376
    s_add_u32 s71, s71, s65
    s_add_u32 s71, s71, 12288
    buffer_load_dwordx4 v[144:147], v14, s[12:15], s71 offen offset:0 sc1
    buffer_load_dwordx4 v[148:151], v14, s[12:15], s71 offen offset:1024 sc1
    s_mul_i32 s33, s46, 28672
    s_add_u32 s33, s33, s53
    s_add_u32 s33, s33, 12288
    buffer_load_dwordx4 v[152:155], v14, s[48:51], s33 offen offset:0 sc1
    buffer_load_dwordx4 v[156:159], v14, s[48:51], s33 offen offset:1024 sc1
    s_waitcnt vmcnt(38)
    v_mfma_f32_32x32x16_bf16 v[192:207], v[160:163], v[168:171], v[192:207]
    v_mfma_f32_32x32x16_bf16 v[208:223], v[160:163], v[172:175], v[208:223]
    v_mfma_f32_32x32x16_bf16 v[240:255], v[164:167], v[172:175], v[240:255]
    v_mfma_f32_32x32x16_bf16 v[224:239], v[164:167], v[168:171], v[224:239]
    s_mul_i32 s71, s54, 229376
    s_add_u32 s71, s71, s65
    s_add_u32 s71, s71, 0
    buffer_load_dwordx4 v[160:163], v14, s[12:15], s71 offen offset:0 sc1
    buffer_load_dwordx4 v[164:167], v14, s[12:15], s71 offen offset:1024 sc1
    s_mul_i32 s33, s54, 28672
    s_add_u32 s33, s33, s53
    s_add_u32 s33, s33, 0
    buffer_load_dwordx4 v[168:171], v14, s[48:51], s33 offen offset:0 sc1
    buffer_load_dwordx4 v[172:175], v14, s[48:51], s33 offen offset:1024 sc1
    s_waitcnt vmcnt(40)
    v_mfma_f32_32x32x16_bf16 v[192:207], v[176:179], v[184:187], v[192:207]
    v_mfma_f32_32x32x16_bf16 v[208:223], v[176:179], v[188:191], v[208:223]
    v_mfma_f32_32x32x16_bf16 v[240:255], v[180:183], v[188:191], v[240:255]
    v_mfma_f32_32x32x16_bf16 v[224:239], v[180:183], v[184:187], v[224:239]
    s_mul_i32 s71, s54, 229376
    s_add_u32 s71, s71, s65
    s_add_u32 s71, s71, 4096
    buffer_load_dwordx4 v[176:179], v14, s[12:15], s71 offen offset:0 sc1
    buffer_load_dwordx4 v[180:183], v14, s[12:15], s71 offen offset:1024 sc1
    s_mul_i32 s33, s54, 28672
    s_add_u32 s33, s33, s53
    s_add_u32 s33, s33, 4096
    buffer_load_dwordx4 v[184:187], v14, s[48:51], s33 offen offset:0 sc1
    buffer_load_dwordx4 v[188:191], v14, s[48:51], s33 offen offset:1024 sc1
    s_waitcnt vmcnt(24)
    s_mov_b64 exec, 1
    s_waitcnt lgkmcnt(0)
    ds_add_u32 v10, v9 offset:12
    s_mov_b64 exec, -1
    v_mfma_f32_32x32x16_bf16 v[192:207], v[16:19], v[24:27], v[192:207]
    v_mfma_f32_32x32x16_bf16 v[208:223], v[16:19], v[28:31], v[208:223]
    v_mfma_f32_32x32x16_bf16 v[240:255], v[20:23], v[28:31], v[240:255]
    v_mfma_f32_32x32x16_bf16 v[224:239], v[20:23], v[24:27], v[224:239]
    s_mul_i32 s71, s54, 229376
    s_add_u32 s71, s71, s65
    s_add_u32 s71, s71, 8192
    buffer_load_dwordx4 v[16:19], v14, s[12:15], s71 offen offset:0 sc1
    buffer_load_dwordx4 v[20:23], v14, s[12:15], s71 offen offset:1024 sc1
    s_mul_i32 s33, s54, 28672
    s_add_u32 s33, s33, s53
    s_add_u32 s33, s33, 8192
    buffer_load_dwordx4 v[24:27], v14, s[48:51], s33 offen offset:0 sc1
    buffer_load_dwordx4 v[28:31], v14, s[48:51], s33 offen offset:1024 sc1
    s_waitcnt vmcnt(24)
    v_mfma_f32_32x32x16_bf16 v[192:207], v[32:35], v[40:43], v[192:207]
    v_mfma_f32_32x32x16_bf16 v[208:223], v[32:35], v[44:47], v[208:223]
    v_mfma_f32_32x32x16_bf16 v[240:255], v[36:39], v[44:47], v[240:255]
    v_mfma_f32_32x32x16_bf16 v[224:239], v[36:39], v[40:43], v[224:239]
    s_mul_i32 s71, s54, 229376
    s_add_u32 s71, s71, s65
    s_add_u32 s71, s71, 12288
    buffer_load_dwordx4 v[32:35], v14, s[12:15], s71 offen offset:0 sc1
    buffer_load_dwordx4 v[36:39], v14, s[12:15], s71 offen offset:1024 sc1
    s_mul_i32 s33, s54, 28672
    s_add_u32 s33, s33, s53
    s_add_u32 s33, s33, 12288
    buffer_load_dwordx4 v[40:43], v14, s[48:51], s33 offen offset:0 sc1
    buffer_load_dwordx4 v[44:47], v14, s[48:51], s33 offen offset:1024 sc1
    s_waitcnt vmcnt(24)
    v_mfma_f32_32x32x16_bf16 v[192:207], v[48:51], v[56:59], v[192:207]
    v_mfma_f32_32x32x16_bf16 v[208:223], v[48:51], v[60:63], v[208:223]
    v_mfma_f32_32x32x16_bf16 v[240:255], v[52:55], v[60:63], v[240:255]
    v_mfma_f32_32x32x16_bf16 v[224:239], v[52:55], v[56:59], v[224:239]
    s_mul_i32 s71, s54, 229376
    s_add_u32 s71, s71, s65
    s_add_u32 s71, s71, 16384
    buffer_load_dwordx4 v[48:51], v14, s[12:15], s71 offen offset:0 sc1
    buffer_load_dwordx4 v[52:55], v14, s[12:15], s71 offen offset:1024 sc1
    s_mov_b32 s47, 30000
KC_q1:
    s_lshl_b32 s34, s44, 7
    s_add_u32 s34, s34, s52
    s_add_u32 s34, s34, 16
    s_load_dwordx4 s[36:39], s[56:57], s34 glc
    s_lshl_b32 s34, s45, 7
    s_add_u32 s34, s34, s52
    s_add_u32 s34, s34, 16
    s_load_dwordx4 s[40:43], s[56:57], s34 glc
    s_lshl_b32 s34, s46, 7
    s_add_u32 s34, s34, s52
    s_add_u32 s34, s34, 16
    s_load_dwordx4 s[24:27], s[56:57], s34 glc
    s_lshl_b32 s34, s54, 7
    s_add_u32 s34, s34, s52
    s_add_u32 s34, s34, 16
    s_load_dwordx4 s[28:31], s[56:57], s34 glc
    s_waitcnt lgkmcnt(0)
    s_and_b64 s[36:37], s[36:37], s[40:41]
    s_and_b64 s[38:39], s[38:39], s[42:43]
    s_and_b64 s[36:37], s[36:37], s[24:25]
    s_and_b64 s[38:39], s[38:39], s[26:27]
    s_and_b64 s[36:37], s[36:37], s[28:29]
    s_and_b64 s[38:39], s[38:39], s[30:31]
    s_and_b32 s36, s36, s37
    s_and_b32 s36, s36, s38
    s_cmp_eq_u32 s36, 1
    s_cbranch_scc1 KC_r1
    s_sleep 4
    s_sub_u32 s47, s47, 1
    s_cbranch_scc0 KC_q1
KC_r1:
    ds_write_b32 v10, v9 offset:24
    s_mul_i32 s33, s54, 28672
    s_add_u32 s33, s33, s53
    s_add_u32 s33, s33, 16384
    buffer_load_dwordx4 v[56:59], v14, s[48:51], s33 offen offset:0 sc1
    buffer_load_dwordx4 v[60:63], v14, s[48:51], s33 offen offset:1024 sc1
    s_waitcnt vmcnt(24)
    v_mfma_f32_32x32x16_bf16 v[192:207], v[128:131], v[136:139], v[192:207]
    v_mfma_f32_32x32x16_bf16 v[208:223], v[128:131], v[140:143], v[208:223]
    v_mfma_f32_32x32x16_bf16 v[240:255], v[132:135], v[140:143], v[240:255]
    v_mfma_f32_32x32x16_bf16 v[224:239], v[132:135], v[136:139], v[224:239]
    s_mul_i32 s71, s54, 229376
    s_add_u32 s71, s71, s65
    s_add_u32 s71, s71, 20480
    buffer_load_dwordx4 v[128:131], v14, s[12:15], s71 offen offset:0 sc1
    buffer_load_dwordx4 v[132:135], v14, s[12:15], s71 offen offset:1024 sc1
    s_mul_i32 s33, s54, 28672
    s_add_u32 s33, s33, s53
    s_add_u32 s33, s33, 20480
    buffer_load_dwordx4 v[136:139], v14, s[48:51], s33 offen offset:0 sc1
    buffer_load_dwordx4 v[140:143], v14, s[48:51], s33 offen offset:1024 sc1
    s_waitcnt vmcnt(24)
    v_mfma_f32_32x32x16_bf16 v[192:207], v[144:147], v[152:155], v[192:207]
    v_mfma_f32_32x32x16_bf16 v[208:223], v[144:147], v[156:159], v[208:223]
    v_mfma_f32_32x32x16_bf16 v[240:255], v[148:151], v[156:159], v[240:255]
    v_mfma_f32_32x32x16_bf16 v[224:239], v[148:151], v[152:155], v[224:239]
    s_mul_i32 s71, s54, 229376
    s_add_u32 s71, s71, s65
    s_add_u32 s71, s71, 24576
    buffer_load_dwordx4 v[144:147], v14, s[12:15], s71 offen offset:0 sc1
    buffer_load_dwordx4 v[148:151], v14, s[12:15], s71 offen offset:1024 sc1
    s_mul_i32 s33, s54, 28672
    s_add_u32 s33, s33, s53
    s_add_u32 s33, s33, 24576
    buffer_load_dwordx4 v[152:155], v14, s[48:51], s33 offen offset:0 sc1
    buffer_load_dwordx4 v[156:159], v14, s[48:51], s33 offen offset:1024 sc1
    s_waitcnt vmcnt(24)
    v_mfma_f32_32x32x16_bf16 v[192:207], v[160:163], v[168:171], v[192:207]
    v_mfma_f32_32x32x16_bf16 v[208:223], v[160:163], v[172:175], v[208:223]
    v_mfma_f32_32x32x16_bf16 v[240:255], v[164:167], v[172:175], v[240:255]
    v_mfma_f32_32x32x16_bf16 v[224:239], v[164:167], v[168:171], v[224:239]
    s_waitcnt vmcnt(20)
    v_mfma_f32_32x32x16_bf16 v[192:207], v[176:179], v[184:187], v[192:207]
    v_mfma_f32_32x32x16_bf16 v[208:223], v[176:179], v[188:191], v[208:223]
    v_mfma_f32_32x32x16_bf16 v[240:255], v[180:183], v[188:191], v[240:255]
    v_mfma_f32_32x32x16_bf16 v[224:239], v[180:183], v[184:187], v[224:239]
    s_waitcnt vmcnt(16)
    v_mfma_f32_32x32x16_bf16 v[192:207], v[16:19], v[24:27], v[192:207]
    v_mfma_f32_32x32x16_bf16 v[208:223], v[16:19], v[28:31], v[208:223]
    v_mfma_f32_32x32x16_bf16 v[240:255], v[20:23], v[28:31], v[240:255]
    v_mfma_f32_32x32x16_bf16 v[224:239], v[20:23], v[24:27], v[224:239]
    s_waitcnt vmcnt(12)
    v_mfma_f32_32x32x16_bf16 v[192:207], v[32:35], v[40:43], v[192:207]
    v_mfma_f32_32x32x16_bf16 v[208:223], v[32:35], v[44:47], v[208:223]
    v_mfma_f32_32x32x16_bf16 v[240:255], v[36:39], v[44:47], v[240:255]
    v_mfma_f32_32x32x16_bf16 v[224:239], v[36:39], v[40:43], v[224:239]
    s_waitcnt vmcnt(8)
    v_mfma_f32_32x32x16_bf16 v[192:207], v[48:51], v[56:59], v[192:207]
    v_mfma_f32_32x32x16_bf16 v[208:223], v[48:51], v[60:63], v[208:223]
    v_mfma_f32_32x32x16_bf16 v[240:255], v[52:55], v[60:63], v[240:255]
    v_mfma_f32_32x32x16_bf16 v[224:239], v[52:55], v[56:59], v[224:239]
    s_waitcnt vmcnt(4)
    v_mfma_f32_32x32x16_bf16 v[192:207], v[128:131], v[136:139], v[192:207]
    v_mfma_f32_32x32x16_bf16 v[208:223], v[128:131], v[140:143], v[208:223]
    v_mfma_f32_32x32x16_bf16 v[240:255], v[132:135], v[140:143], v[240:255]
    v_mfma_f32_32x32x16_bf16 v[224:239], v[132:135], v[136:139], v[224:239]
    s_waitcnt vmcnt(0)
    v_mfma_f32_32x32x16_bf16 v[192:207], v[144:147], v[152:155], v[192:207]
    v_mfma_f32_32x32x16_bf16 v[208:223], v[144:147], v[156:159], v[208:223]
    v_mfma_f32_32x32x16_bf16 v[240:255], v[148:151], v[156:159], v[240:255]
    v_mfma_f32_32x32x16_bf16 v[224:239], v[148:151], v[152:155], v[224:239]
    s_branch KC_slow3
KC_lo2:
    s_and_b32 s28, s36, s37
    s_and_b32 s28, s28, s38
    s_and_b32 s28, s28, s39
    s_and_b32 s28, s28, s40
    s_and_b32 s28, s28, s41
    s_and_b32 s28, s28, s42
    s_cmp_eq_u32 s28, 1
    s_cbranch_scc1 KC_gtg
    s_mov_b64 exec, 1
    s_waitcnt vmcnt(0)
    buffer_store_dword v9, v8, s[8:11], s33 offen sc1
    s_mov_b64 exec, -1
    s_mov_b32 s47, 30000
KC_plg0:
    s_load_dwordx8 s[36:43], s[56:57], s52 glc
    s_waitcnt lgkmcnt(0)
    s_and_b32 s28, s36, s37
    s_and_b32 s28, s28, s38
    s_and_b32 s28, s28, s39
    s_and_b32 s28, s28, s40
    s_and_b32 s28, s28, s41
    s_and_b32 s28, s28, s42
    s_cmp_eq_u32 s28, 1
    s_cbranch_scc1 KC_gtg0
    s_sleep 4
    s_sub_u32 s47, s47, 1
    s_cbranch_scc0 KC_plg0
KC_gtg0:
    s_add_u32 s30, s53, 0
    buffer_load_dwordx4 v[128:131], v14, s[48:51], s30 offen offset:0 sc1
    buffer_load_dwordx4 v[132:135], v14, s[48:51], s30 offen offset:1024 sc1
    s_add_u32 s30, s53, 4096
    buffer_load_dwordx4 v[136:139], v14, s[48:51], s30 offen offset:0 sc1
    buffer_load_dwordx4 v[140:143], v14, s[48:51], s30 offen offset:1024 sc1
    s_add_u32 s30, s53, 8192
    buffer_load_dwordx4 v[144:147], v14, s[48:51], s30 offen offset:0 sc1
    buffer_load_dwordx4 v[148:151], v14, s[48:51], s30 offen offset:1024 sc1
    s_add_u32 s30, s53, 12288
    buffer_load_dwordx4 v[152:155], v14, s[48:51], s30 offen offset:0 sc1
    buffer_load_dwordx4 v[156:159], v14, s[48:51], s30 offen offset:1024 sc1
    s_add_u32 s30, s53, 16384
    buffer_load_dwordx4 v[160:163], v14, s[48:51], s30 offen offset:0 sc1
    buffer_load_dwordx4 v[164:167], v14, s[48:51], s30 offen offset:1024 sc1
    s_add_u32 s30, s53, 20480
    buffer_load_dwordx4 v[168:171], v14, s[48:51], s30 offen offset:0 sc1
    buffer_load_dwordx4 v[172:175], v14, s[48:51], s30 offen offset:1024 sc1
    s_add_u32 s30, s53, 24576
    buffer_load_dwordx4 v[176:179], v14, s[48:51], s30 offen offset:0 sc1
    buffer_load_dwordx4 v[180:183], v14, s[48:51], s30 offen offset:1024 sc1
    s_branch KC_lo3
KC_gtg:
    s_add_u32 s30, s53, 0
    buffer_load_dwordx4 v[128:131], v14, s[48:51], s30 offen offset:0 sc1
    buffer_load_dwordx4 v[132:135], v14, s[48:51], s30 offen offset:1024 sc1
    s_add_u32 s30, s53, 4096
    buffer_load_dwordx4 v[136:139], v14, s[48:51], s30 offen offset:0 sc1
    buffer_load_dwordx4 v[140:143], v14, s[48:51], s30 offen offset:1024 sc1
    s_add_u32 s30, s53, 8192
    buffer_load_dwordx4 v[144:147], v14, s[48:51], s30 offen offset:0 sc1
    buffer_load_dwordx4 v[148:151], v14, s[48:51], s30 offen offset:1024 sc1
    s_add_u32 s30, s53, 12288
    buffer_load_dwordx4 v[152:155], v14, s[48:51], s30 offen offset:0 sc1
    buffer_load_dwordx4 v[156:159], v14, s[48:51], s30 offen offset:1024 sc1
    s_add_u32 s30, s53, 16384
    buffer_load_dwordx4 v[160:163], v14, s[48:51], s30 offen offset:0 sc1
    buffer_load_dwordx4 v[164:167], v14, s[48:51], s30 offen offset:1024 sc1
    s_add_u32 s30, s53, 20480
    buffer_load_dwordx4 v[168:171], v14, s[48:51], s30 offen offset:0 sc1
    buffer_load_dwordx4 v[172:175], v14, s[48:51], s30 offen offset:1024 sc1
    s_add_u32 s30, s53, 24576
    buffer_load_dwordx4 v[176:179], v14, s[48:51], s30 offen offset:0 sc1
    buffer_load_dwordx4 v[180:183], v14, s[48:51], s30 offen offset:1024 sc1
    s_mov_b64 exec, 1
    s_waitcnt vmcnt(14)
    buffer_store_dword v9, v8, s[8:11], s33 offen sc1
    s_mov_b64 exec, -1
KC_lo3:
    s_setprio 0
    s_mov_b32 s47, 30000
KC_lsk:
    ds_read_b32 v12, v10 offset:12
    s_sub_u32 s47, s47, 1
    s_cbranch_scc1 KC_lgk
    s_waitcnt lgkmcnt(0)
    v_cmp_le_u32 vcc, 4, v12
    s_cbranch_vccnz KC_lgk
    s_sleep 1
    s_branch KC_lsk
KC_lgk:
    s_lshl_b32 s55, s3, 14
    v_add_u32 v13, s55, v5
    ds_read_b128 v[16:19], v13 offset:0
    ds_read_b128 v[20:23], v13 offset:1024
    ds_read_b128 v[24:27], v13 offset:2048
    ds_read_b128 v[28:31], v13 offset:3072
    ds_read_b128 v[32:35], v13 offset:4096
    ds_read_b128 v[36:39], v13 offset:5120
    ds_read_b128 v[40:43], v13 offset:6144
    ds_read_b128 v[44:47], v13 offset:7168
    ds_read_b128 v[48:51], v13 offset:8192
    ds_read_b128 v[52:55], v13 offset:9216
    ds_read_b128 v[56:59], v13 offset:10240
    ds_read_b128 v[60:63], v13 offset:11264
    ds_read_b128 v[88:91], v13 offset:12288
    ds_read_b128 v[92:95], v13 offset:13312
    ds_read_b128 v[80:83], v13 offset:14336
    ds_read_b128 v[84:87], v13 offset:15360
    s_waitcnt vmcnt(6) lgkmcnt(0)
    s_load_dwordx8 s[36:43], s[56:57], s23 glc
    v_mfma_f32_32x32x16_bf16 v[192:207], v[16:19], v[128:131], 0
    v_mfma_f32_32x32x16_bf16 v[208:223], v[16:19], v[132:135], 0
    v_mfma_f32_32x32x16_bf16 v[240:255], v[20:23], v[132:135], 0
    v_mfma_f32_32x32x16_bf16 v[224:239], v[20:23], v[128:131], 0
    v_mfma_f32_32x32x16_bf16 v[192:207], v[24:27], v[136:139], v[192:207]
    v_mfma_f32_32x32x16_bf16 v[208:223], v[24:27], v[140:143], v[208:223]
    v_mfma_f32_32x32x16_bf16 v[240:255], v[28:31], v[140:143], v[240:255]
    v_mfma_f32_32x32x16_bf16 v[224:239], v[28:31], v[136:139], v[224:239]
    v_mfma_f32_32x32x16_bf16 v[192:207], v[32:35], v[144:147], v[192:207]
    v_mfma_f32_32x32x16_bf16 v[208:223], v[32:35], v[148:151], v[208:223]
    v_mfma_f32_32x32x16_bf16 v[240:255], v[36:39], v[148:151], v[240:255]
    v_mfma_f32_32x32x16_bf16 v[224:239], v[36:39], v[144:147], v[224:239]
    v_mfma_f32_32x32x16_bf16 v[192:207], v[40:43], v[152:155], v[192:207]
    v_mfma_f32_32x32x16_bf16 v[208:223], v[40:43], v[156:159], v[208:223]
    v_mfma_f32_32x32x16_bf16 v[240:255], v[44:47], v[156:159], v[240:255]
    v_mfma_f32_32x32x16_bf16 v[224:239], v[44:47], v[152:155], v[224:239]
KC_hj:
    s_waitcnt lgkmcnt(0)
    s_and_b32 s28, s36, s37
    s_and_b32 s28, s28, s38
    s_and_b32 s28, s28, s39
    s_cmp_eq_u32 s28, 1
    s_cbranch_scc0 KC_slow2
    s_add_u32 s30, s53, 0
    buffer_load_dwordx4 v[128:131], v15, s[48:51], s30 offen offset:0 sc1
    buffer_load_dwordx4 v[132:135], v15, s[48:51], s30 offen offset:1024 sc1
    s_add_u32 s30, s53, 4096
    buffer_load_dwordx4 v[136:139], v15, s[48:51], s30 offen offset:0 sc1
    buffer_load_dwordx4 v[140:143], v15, s[48:51], s30 offen offset:1024 sc1
    s_add_u32 s30, s53, 8192
    buffer_load_dwordx4 v[144:147], v15, s[48:51], s30 offen offset:0 sc1
    buffer_load_dwordx4 v[148:151], v15, s[48:51], s30 offen offset:1024 sc1
    s_add_u32 s30, s53, 12288
    buffer_load_dwordx4 v[152:155], v15, s[48:51], s30 offen offset:0 sc1
    buffer_load_dwordx4 v[156:159], v15, s[48:51], s30 offen offset:1024 sc1
    s_waitcnt vmcnt(8)
    v_mfma_f32_32x32x16_bf16 v[192:207], v[48:51], v[160:163], v[192:207]
    v_mfma_f32_32x32x16_bf16 v[208:223], v[48:51], v[164:167], v[208:223]
    v_mfma_f32_32x32x16_bf16 v[240:255], v[52:55], v[164:167], v[240:255]
    v_mfma_f32_32x32x16_bf16 v[224:239], v[52:55], v[160:163], v[224:239]
    v_mfma_f32_32x32x16_bf16 v[192:207], v[56:59], v[168:171], v[192:207]
    v_mfma_f32_32x32x16_bf16 v[208:223], v[56:59], v[172:175], v[208:223]
    v_mfma_f32_32x32x16_bf16 v[240:255], v[60:63], v[172:175], v[240:255]
    v_mfma_f32_32x32x16_bf16 v[224:239], v[60:63], v[168:171], v[224:239]
    v_mfma_f32_32x32x16_bf16 v[192:207], v[88:91], v[176:179], v[192:207]
    v_mfma_f32_32x32x16_bf16 v[208:223], v[88:91], v[180:183], v[208:223]
    v_mfma_f32_32x32x16_bf16 v[240:255], v[92:95], v[180:183], v[240:255]
    v_mfma_f32_32x32x16_bf16 v[224:239], v[92:95], v[176:179], v[224:239]
    s_branch KC_b2
KC_slow2:
    s_waitcnt vmcnt(0)
    v_mfma_f32_32x32x16_bf16 v[192:207], v[48:51], v[160:163], v[192:207]
    v_mfma_f32_32x32x16_bf16 v[208:223], v[48:51], v[164:167], v[208:223]
    v_mfma_f32_32x32x16_bf16 v[240:255], v[52:55], v[164:167], v[240:255]
    v_mfma_f32_32x32x16_bf16 v[224:239], v[52:55], v[160:163], v[224:239]
    v_mfma_f32_32x32x16_bf16 v[192:207], v[56:59], v[168:171], v[192:207]
    v_mfma_f32_32x32x16_bf16 v[208:223], v[56:59], v[172:175], v[208:223]
    v_mfma_f32_32x32x16_bf16 v[240:255], v[60:63], v[172:175], v[240:255]
    v_mfma_f32_32x32x16_bf16 v[224:239], v[60:63], v[168:171], v[224:239]
    v_mfma_f32_32x32x16_bf16 v[192:207], v[88:91], v[176:179], v[192:207]
    v_mfma_f32_32x32x16_bf16 v[208:223], v[88:91], v[180:183], v[208:223]
    v_mfma_f32_32x32x16_bf16 v[240:255], v[92:95], v[180:183], v[240:255]
    v_mfma_f32_32x32x16_bf16 v[224:239], v[92:95], v[176:179], v[224:239]
KC_slow3:
    s_mov_b32 s47, 30000
KC_plh:
    s_load_dwordx8 s[36:43], s[56:57], s23 glc
    s_waitcnt lgkmcnt(0)
    s_and_b32 s28, s36, s37
    s_and_b32 s28, s28, s38
    s_and_b32 s28, s28, s39
    s_cmp_eq_u32 s28, 1
    s_cbranch_scc1 KC_gth
    s_sleep 4
    s_sub_u32 s47, s47, 1
    s_cbranch_scc0 KC_plh
KC_gth:
    s_add_u32 s30, s53, 0
    buffer_load_dwordx4 v[128:131], v15, s[48:51], s30 offen offset:0 sc1
    buffer_load_dwordx4 v[132:135], v15, s[48:51], s30 offen offset:1024 sc1
    s_add_u32 s30, s53, 4096
    buffer_load_dwordx4 v[136:139], v15, s[48:51], s30 offen offset:0 sc1
    buffer_load_dwordx4 v[140:143], v15, s[48:51], s30 offen offset:1024 sc1
    s_add_u32 s30, s53, 8192
    buffer_load_dwordx4 v[144:147], v15, s[48:51], s30 offen offset:0 sc1
    buffer_load_dwordx4 v[148:151], v15, s[48:51], s30 offen offset:1024 sc1
    s_add_u32 s30, s53, 12288
    buffer_load_dwordx4 v[152:155], v15, s[48:51], s30 offen offset:0 sc1
    buffer_load_dwordx4 v[156:159], v15, s[48:51], s30 offen offset:1024 sc1
KC_b2:
    s_load_dwordx8 s[36:43], s[56:57], s23 glc
    v_and_b32 v9, 7, v0
    v_lshrrev_b32 v1, 3, v0
    s_lshl_b32 s31, s20, 3
    v_add_u32 v11, s31, v9
    v_lshlrev_b32 v12, 5, v11
    s_mov_b32 s32, 2107392
    buffer_load_dwordx4 v[24:27], v12, s[8:11], s32 offen sc1
    buffer_load_dwordx4 v[28:31], v12, s[8:11], s32 offen offset:16 sc1
    v_sub_u32 v32, 63, v11
    s_cmp_lt_u32 s20, 4
    s_cselect_b64 vcc, -1, 0
    s_cselect_b32 s33, 0, 4
    s_mov_b32 s34, 0x01000c0c
    s_cselect_b32 s34, 0x05040c0c, s34
    s_add_u32 s35, s34, 0x02020000
    v_cndmask_b32 v32, v32, v11, vcc
    v_lshrrev_b32 v33, 2, v32
    v_and_b32 v32, 3, v32
    v_lshl_add_u32 v32, v33, 3, v32
    v_add_u32 v32, s33, v32
    v_lshlrev_b32 v32, 10, v32
    v_lshl_add_u32 v32, v1, 4, v32
    v_sub_u32 v33, 64, v11
    v_and_b32 v33, 31, v33
    v_lshrrev_b32 v34, 2, v33
    v_and_b32 v33, 3, v33
    v_lshl_add_u32 v33, v34, 3, v33
    v_add_u32 v33, 4, v33
    v_lshlrev_b32 v33, 10, v33
    v_lshl_add_u32 v33, v1, 4, v33
    s_lshl_b32 s31, s21, 16
    buffer_load_dwordx4 v[16:19], v32, s[16:19], s31 offen sc1
    buffer_load_ushort v20, v33, s[16:19], s31 offen sc1
    v_and_b32 v32, 31, v1
    v_lshlrev_b32 v32, 6, v32
    v_add_u32 v32, s21, v32
    v_add_u32 v33, 32, v32
    v_sub_u32 v34, 0x800, v32
    s_cmp_eq_u32 s21, 0
    s_cselect_b64 vcc, -1, 0
    v_cndmask_b32 v33, v34, v33, vcc
    s_cmp_lt_u32 s3, 4
    s_cselect_b64 vcc, -1, 0
    v_cndmask_b32 v32, v33, v32, vcc
    v_lshlrev_b32 v32, 10, v32
    v_lshl_add_u32 v11, v11, 4, v32
    v_mul_u32_u24 v21, 4224, v4
    v_lshl_add_u32 v21, v3, 4, v21
    s_mul_i32 s31, s3, 8448
    s_add_u32 s31, s31, 65536
    v_add_u32 v21, s31, v21
    v_mul_u32_u24 v22, 1056, v9
    v_lshl_add_u32 v22, v1, 4, v22
    v_add_u32 v22, 65536, v22
    s_waitcnt lgkmcnt(0)
    s_and_b32 s28, s40, s41
    s_and_b32 s28, s28, s42
    s_cmp_eq_u32 s28, 1
    s_cbranch_scc0 KC_slow4
    s_add_u32 s30, s53, 16384
    buffer_load_dwordx4 v[160:163], v15, s[48:51], s30 offen offset:0 sc1
    buffer_load_dwordx4 v[164:167], v15, s[48:51], s30 offen offset:1024 sc1
    s_add_u32 s30, s53, 20480
    buffer_load_dwordx4 v[168:171], v15, s[48:51], s30 offen offset:0 sc1
    buffer_load_dwordx4 v[172:175], v15, s[48:51], s30 offen offset:1024 sc1
    s_add_u32 s30, s53, 24576
    buffer_load_dwordx4 v[176:179], v15, s[48:51], s30 offen offset:0 sc1
    buffer_load_dwordx4 v[180:183], v15, s[48:51], s30 offen offset:1024 sc1
    s_waitcnt vmcnt(16)
    v_mfma_f32_32x32x16_bf16 v[192:207], v[80:83], v[128:131], v[192:207]
    v_mfma_f32_32x32x16_bf16 v[208:223], v[80:83], v[132:135], v[208:223]
    v_mfma_f32_32x32x16_bf16 v[240:255], v[84:87], v[132:135], v[240:255]
    v_mfma_f32_32x32x16_bf16 v[224:239], v[84:87], v[128:131], v[224:239]
    s_waitcnt vmcnt(14)
    v_mfma_f32_32x32x16_bf16 v[192:207], v[64:67], v[136:139], v[192:207]
    v_mfma_f32_32x32x16_bf16 v[208:223], v[64:67], v[140:143], v[208:223]
    v_mfma_f32_32x32x16_bf16 v[240:255], v[68:71], v[140:143], v[240:255]
    v_mfma_f32_32x32x16_bf16 v[224:239], v[68:71], v[136:139], v[224:239]
    s_waitcnt vmcnt(12)
    v_mfma_f32_32x32x16_bf16 v[192:207], v[72:75], v[144:147], v[192:207]
    v_mfma_f32_32x32x16_bf16 v[208:223], v[72:75], v[148:151], v[208:223]
    v_mfma_f32_32x32x16_bf16 v[240:255], v[76:79], v[148:151], v[240:255]
    v_mfma_f32_32x32x16_bf16 v[224:239], v[76:79], v[144:147], v[224:239]
    s_waitcnt vmcnt(10)
    v_mfma_f32_32x32x16_bf16 v[192:207], v[96:99], v[152:155], v[192:207]
    v_mfma_f32_32x32x16_bf16 v[208:223], v[96:99], v[156:159], v[208:223]
    v_mfma_f32_32x32x16_bf16 v[240:255], v[100:103], v[156:159], v[240:255]
    v_mfma_f32_32x32x16_bf16 v[224:239], v[100:103], v[152:155], v[224:239]
    s_branch KC_b3
KC_slow4:
    s_waitcnt vmcnt(10)
    v_mfma_f32_32x32x16_bf16 v[192:207], v[80:83], v[128:131], v[192:207]
    v_mfma_f32_32x32x16_bf16 v[208:223], v[80:83], v[132:135], v[208:223]
    v_mfma_f32_32x32x16_bf16 v[240:255], v[84:87], v[132:135], v[240:255]
    v_mfma_f32_32x32x16_bf16 v[224:239], v[84:87], v[128:131], v[224:239]
    s_waitcnt vmcnt(8)
    v_mfma_f32_32x32x16_bf16 v[192:207], v[64:67], v[136:139], v[192:207]
    v_mfma_f32_32x32x16_bf16 v[208:223], v[64:67], v[140:143], v[208:223]
    v_mfma_f32_32x32x16_bf16 v[240:255], v[68:71], v[140:143], v[240:255]
    v_mfma_f32_32x32x16_bf16 v[224:239], v[68:71], v[136:139], v[224:239]
    s_waitcnt vmcnt(6)
    v_mfma_f32_32x32x16_bf16 v[192:207], v[72:75], v[144:147], v[192:207]
    v_mfma_f32_32x32x16_bf16 v[208:223], v[72:75], v[148:151], v[208:223]
    v_mfma_f32_32x32x16_bf16 v[240:255], v[76:79], v[148:151], v[240:255]
    v_mfma_f32_32x32x16_bf16 v[224:239], v[76:79], v[144:147], v[224:239]
    s_waitcnt vmcnt(4)
    v_mfma_f32_32x32x16_bf16 v[192:207], v[96:99], v[152:155], v[192:207]
    v_mfma_f32_32x32x16_bf16 v[208:223], v[96:99], v[156:159], v[208:223]
    v_mfma_f32_32x32x16_bf16 v[240:255], v[100:103], v[156:159], v[240:255]
    v_mfma_f32_32x32x16_bf16 v[224:239], v[100:103], v[152:155], v[224:239]
    s_mov_b32 s47, 30000
KC_pl3:
    s_load_dwordx8 s[36:43], s[56:57], s23 glc
    s_waitcnt lgkmcnt(0)
    s_and_b32 s28, s40, s41
    s_and_b32 s28, s28, s42
    s_cmp_eq_u32 s28, 1
    s_cbranch_scc1 KC_gt3
    s_sleep 4
    s_sub_u32 s47, s47, 1
    s_cbranch_scc0 KC_pl3
KC_gt3:
    s_add_u32 s30, s53, 16384
    buffer_load_dwordx4 v[160:163], v15, s[48:51], s30 offen offset:0 sc1
    buffer_load_dwordx4 v[164:167], v15, s[48:51], s30 offen offset:1024 sc1
    s_add_u32 s30, s53, 20480
    buffer_load_dwordx4 v[168:171], v15, s[48:51], s30 offen offset:0 sc1
    buffer_load_dwordx4 v[172:175], v15, s[48:51], s30 offen offset:1024 sc1
    s_add_u32 s30, s53, 24576
    buffer_load_dwordx4 v[176:179], v15, s[48:51], s30 offen offset:0 sc1
    buffer_load_dwordx4 v[180:183], v15, s[48:51], s30 offen offset:1024 sc1
KC_b3:
    s_waitcnt vmcnt(6)
    v_perm_b32 v32, v16, v20, s34
    v_perm_b32 v33, v16, v19, s35
    v_perm_b32 v34, v17, v19, s34
    v_perm_b32 v35, v17, v18, s35
    v_perm_b32 v36, v18, v18, s34
    v_perm_b32 v37, v18, v17, s35
    v_perm_b32 v38, v19, v17, s34
    v_perm_b32 v39, v19, v16, s35
    s_mov_b32 s60, s68
    s_mov_b32 s61, s69
    s_mov_b32 s62, 0x200000
    s_mov_b32 s63, 0x20000
    s_mov_b32 s47, 30000
KC_lsd:
    ds_read_b32 v12, v10 offset:8
    s_sub_u32 s47, s47, 1
    s_cbranch_scc1 KC_lgd
    s_waitcnt lgkmcnt(0)
    v_cmp_le_u32 vcc, 7, v12
    s_cbranch_vccnz KC_lgd
    s_sleep 1
    s_branch KC_lsd
KC_lgd:
    s_waitcnt vmcnt(4)
    v_mfma_f32_32x32x16_bf16 v[192:207], v[104:107], v[160:163], v[192:207]
    v_mfma_f32_32x32x16_bf16 v[208:223], v[104:107], v[164:167], v[208:223]
    v_mfma_f32_32x32x16_bf16 v[240:255], v[108:111], v[164:167], v[240:255]
    v_mfma_f32_32x32x16_bf16 v[224:239], v[108:111], v[160:163], v[224:239]
    s_waitcnt vmcnt(2)
    v_mfma_f32_32x32x16_bf16 v[192:207], v[112:115], v[168:171], v[192:207]
    v_mfma_f32_32x32x16_bf16 v[208:223], v[112:115], v[172:175], v[208:223]
    v_mfma_f32_32x32x16_bf16 v[240:255], v[116:119], v[172:175], v[240:255]
    v_mfma_f32_32x32x16_bf16 v[224:239], v[116:119], v[168:171], v[224:239]
    s_waitcnt vmcnt(0)
    v_mfma_f32_32x32x16_bf16 v[192:207], v[120:123], v[176:179], v[192:207]
    v_mfma_f32_32x32x16_bf16 v[208:223], v[120:123], v[180:183], v[208:223]
    v_mfma_f32_32x32x16_bf16 v[240:255], v[124:127], v[180:183], v[240:255]
    v_mfma_f32_32x32x16_bf16 v[224:239], v[124:127], v[176:179], v[224:239]
    s_nop 9
    v_cvt_pk_bf16_f32 v144, v208, v212
    v_cvt_pk_bf16_f32 v145, v216, v220
    v_cvt_pk_bf16_f32 v146, v240, v244
    v_cvt_pk_bf16_f32 v147, v248, v252
    ds_write_b128 v21, v[144:147] offset:512
    v_cvt_pk_bf16_f32 v148, v209, v213
    v_cvt_pk_bf16_f32 v149, v217, v221
    v_cvt_pk_bf16_f32 v150, v241, v245
    v_cvt_pk_bf16_f32 v151, v249, v253
    ds_write_b128 v21, v[148:151] offset:1568
    v_cvt_pk_bf16_f32 v152, v210, v214
    v_cvt_pk_bf16_f32 v153, v218, v222
    v_cvt_pk_bf16_f32 v154, v242, v246
    v_cvt_pk_bf16_f32 v155, v250, v254
    ds_write_b128 v21, v[152:155] offset:2624
    v_cvt_pk_bf16_f32 v156, v211, v215
    v_cvt_pk_bf16_f32 v157, v219, v223
    v_cvt_pk_bf16_f32 v158, v243, v247
    v_cvt_pk_bf16_f32 v159, v251, v255
    ds_write_b128 v21, v[156:159] offset:3680
    v_cvt_pk_bf16_f32 v128, v192, v196
    v_cvt_pk_bf16_f32 v129, v200, v204
    v_cvt_pk_bf16_f32 v130, v224, v228
    v_cvt_pk_bf16_f32 v131, v232, v236
    ds_write_b128 v21, v[128:131] offset:0
    v_cvt_pk_bf16_f32 v132, v193, v197
    v_cvt_pk_bf16_f32 v133, v201, v205
    v_cvt_pk_bf16_f32 v134, v225, v229
    v_cvt_pk_bf16_f32 v135, v233, v237
    ds_write_b128 v21, v[132:135] offset:1056
    v_cvt_pk_bf16_f32 v136, v194, v198
    v_cvt_pk_bf16_f32 v137, v202, v206
    v_cvt_pk_bf16_f32 v138, v226, v230
    v_cvt_pk_bf16_f32 v139, v234, v238
    ds_write_b128 v21, v[136:139] offset:2112
    v_cvt_pk_bf16_f32 v140, v195, v199
    v_cvt_pk_bf16_f32 v141, v203, v207
    v_cvt_pk_bf16_f32 v142, v227, v231
    v_cvt_pk_bf16_f32 v143, v235, v239
    ds_write_b128 v21, v[140:143] offset:3168
    s_waitcnt lgkmcnt(0)
    s_barrier
    ds_read_b128 v[96:99], v22 offset:0
    ds_read_b128 v[100:103], v22 offset:8448
    ds_read_b128 v[104:107], v22 offset:16896
    ds_read_b128 v[108:111], v22 offset:25344
    ds_read_b128 v[112:115], v22 offset:33792
    ds_read_b128 v[116:119], v22 offset:42240
    ds_read_b128 v[120:123], v22 offset:50688
    ds_read_b128 v[124:127], v22 offset:59136
    s_waitcnt lgkmcnt(7)
    v_lshlrev_b32 v64, 16, v96
    v_and_b32 v65, s58, v96
    v_lshlrev_b32 v66, 16, v97
    v_and_b32 v67, s58, v97
    v_lshlrev_b32 v68, 16, v98
    v_and_b32 v69, s58, v98
    v_lshlrev_b32 v70, 16, v99
    v_and_b32 v71, s58, v99
    s_waitcnt lgkmcnt(6)
    v_lshlrev_b32 v72, 16, v100
    v_and_b32 v73, s58, v100
    v_lshlrev_b32 v74, 16, v101
    v_and_b32 v75, s58, v101
    v_lshlrev_b32 v76, 16, v102
    v_and_b32 v77, s58, v102
    v_lshlrev_b32 v78, 16, v103
    v_and_b32 v79, s58, v103
    v_pk_add_f32 v[64:65], v[64:65], v[72:73]
    v_pk_add_f32 v[66:67], v[66:67], v[74:75]
    v_pk_add_f32 v[68:69], v[68:69], v[76:77]
    v_pk_add_f32 v[70:71], v[70:71], v[78:79]
    s_waitcnt lgkmcnt(5)
    v_lshlrev_b32 v72, 16, v104
    v_and_b32 v73, s58, v104
    v_lshlrev_b32 v74, 16, v105
    v_and_b32 v75, s58, v105
    v_lshlrev_b32 v76, 16, v106
    v_and_b32 v77, s58, v106
    v_lshlrev_b32 v78, 16, v107
    v_and_b32 v79, s58, v107
    v_pk_add_f32 v[64:65], v[64:65], v[72:73]
    v_pk_add_f32 v[66:67], v[66:67], v[74:75]
    v_pk_add_f32 v[68:69], v[68:69], v[76:77]
    v_pk_add_f32 v[70:71], v[70:71], v[78:79]
    s_waitcnt lgkmcnt(4)
    v_lshlrev_b32 v72, 16, v108
    v_and_b32 v73, s58, v108
    v_lshlrev_b32 v74, 16, v109
    v_and_b32 v75, s58, v109
    v_lshlrev_b32 v76, 16, v110
    v_and_b32 v77, s58, v110
    v_lshlrev_b32 v78, 16, v111
    v_and_b32 v79, s58, v111
    v_pk_add_f32 v[64:65], v[64:65], v[72:73]
    v_pk_add_f32 v[66:67], v[66:67], v[74:75]
    v_pk_add_f32 v[68:69], v[68:69], v[76:77]
    v_pk_add_f32 v[70:71], v[70:71], v[78:79]
    s_waitcnt lgkmcnt(3)
    v_lshlrev_b32 v72, 16, v112
    v_and_b32 v73, s58, v112
    v_lshlrev_b32 v74, 16, v113
    v_and_b32 v75, s58, v113
    v_lshlrev_b32 v76, 16, v114
    v_and_b32 v77, s58, v114
    v_lshlrev_b32 v78, 16, v115
    v_and_b32 v79, s58, v115
    v_pk_add_f32 v[64:65], v[64:65], v[72:73]
    v_pk_add_f32 v[66:67], v[66:67], v[74:75]
    v_pk_add_f32 v[68:69], v[68:69], v[76:77]
    v_pk_add_f32 v[70:71], v[70:71], v[78:79]
    s_waitcnt lgkmcnt(2)
    v_lshlrev_b32 v72, 16, v116
    v_and_b32 v73, s58, v116
    v_lshlrev_b32 v74, 16, v117
    v_and_b32 v75, s58, v117
    v_lshlrev_b32 v76, 16, v118
    v_and_b32 v77, s58, v118
    v_lshlrev_b32 v78, 16, v119
    v_and_b32 v79, s58, v119
    v_pk_add_f32 v[64:65], v[64:65], v[72:73]
    v_pk_add_f32 v[66:67], v[66:67], v[74:75]
    v_pk_add_f32 v[68:69], v[68:69], v[76:77]
    v_pk_add_f32 v[70:71], v[70:71], v[78:79]
    s_waitcnt lgkmcnt(1)
    v_lshlrev_b32 v72, 16, v120
    v_and_b32 v73, s58, v120
    v_lshlrev_b32 v74, 16, v121
    v_and_b32 v75, s58, v121
    v_lshlrev_b32 v76, 16, v122
    v_and_b32 v77, s58, v122
    v_lshlrev_b32 v78, 16, v123
    v_and_b32 v79, s58, v123
    v_pk_add_f32 v[64:65], v[64:65], v[72:73]
    v_pk_add_f32 v[66:67], v[66:67], v[74:75]
    v_pk_add_f32 v[68:69], v[68:69], v[76:77]
    v_pk_add_f32 v[70:71], v[70:71], v[78:79]
    s_waitcnt lgkmcnt(0)
    v_lshlrev_b32 v72, 16, v124
    v_and_b32 v73, s58, v124
    v_lshlrev_b32 v74, 16, v125
    v_and_b32 v75, s58, v125
    v_lshlrev_b32 v76, 16, v126
    v_and_b32 v77, s58, v126
    v_lshlrev_b32 v78, 16, v127
    v_and_b32 v79, s58, v127
    v_pk_add_f32 v[64:65], v[64:65], v[72:73]
    v_pk_add_f32 v[66:67], v[66:67], v[74:75]
    v_pk_add_f32 v[68:69], v[68:69], v[76:77]
    v_pk_add_f32 v[70:71], v[70:71], v[78:79]
    v_fmac_f32 v32, v24, v64
    v_fmac_f32 v33, v25, v65
    v_fmac_f32 v34, v26, v66
    v_fmac_f32 v35, v27, v67
    v_fmac_f32 v36, v28, v68
    v_fmac_f32 v37, v29, v69
    v_fmac_f32 v38, v30, v70
    v_fmac_f32 v39, v31, v71
    v_cvt_pk_bf16_f32 v48, v32, v33
    v_cvt_pk_bf16_f32 v49, v34, v35
    v_cvt_pk_bf16_f32 v50, v36, v37
    v_cvt_pk_bf16_f32 v51, v38, v39
    buffer_store_dwordx4 v[48:51], v11, s[60:63], 0 offen sc1
KC_end:
    s_endpgm
KC_pre:
    v_and_b32 v192, 63, v0
    s_bfe_u32 s48, s2, 0x30003
    s_add_u32 s49, s65, s48
    s_and_b32 s49, s49, 1
    s_lshl_b32 s49, s49, 3
    s_and_b32 s50, s65, 1
    s_lshl_b32 s50, s50, 3
    s_lshl_b32 s51, s65, 13
    s_add_u32 s51, s51, 65536
    s_add_u32 s52, s49, 0
    v_xor_b32 v184, s52, v192
    v_lshlrev_b32 v184, 4, v184
    s_add_u32 s52, s50, 0
    v_xor_b32 v176, s52, v192
    v_lshl_add_u32 v176, v176, 4, s51
    s_add_u32 s52, s49, 1
    v_xor_b32 v185, s52, v192
    v_lshlrev_b32 v185, 4, v185
    s_add_u32 s52, s50, 1
    v_xor_b32 v177, s52, v192
    v_lshl_add_u32 v177, v177, 4, s51
    s_add_u32 s52, s49, 2
    v_xor_b32 v186, s52, v192
    v_lshlrev_b32 v186, 4, v186
    s_add_u32 s52, s50, 2
    v_xor_b32 v178, s52, v192
    v_lshl_add_u32 v178, v178, 4, s51
    s_add_u32 s52, s49, 3
    v_xor_b32 v187, s52, v192
    v_lshlrev_b32 v187, 4, v187
    s_add_u32 s52, s50, 3
    v_xor_b32 v179, s52, v192
    v_lshl_add_u32 v179, v179, 4, s51
    s_add_u32 s52, s49, 4
    v_xor_b32 v188, s52, v192
    v_lshlrev_b32 v188, 4, v188
    s_add_u32 s52, s50, 4
    v_xor_b32 v180, s52, v192
    v_lshl_add_u32 v180, v180, 4, s51
    s_add_u32 s52, s49, 5
    v_xor_b32 v189, s52, v192
    v_lshlrev_b32 v189, 4, v189
    s_add_u32 s52, s50, 5
    v_xor_b32 v181, s52, v192
    v_lshl_add_u32 v181, v181, 4, s51
    s_add_u32 s52, s49, 6
    v_xor_b32 v190, s52, v192
    v_lshlrev_b32 v190, 4, v190
    s_add_u32 s52, s50, 6
    v_xor_b32 v182, s52, v192
    v_lshl_add_u32 v182, v182, 4, s51
    s_add_u32 s52, s49, 7
    v_xor_b32 v191, s52, v192
    v_lshlrev_b32 v191, 4, v191
    s_add_u32 s52, s50, 7
    v_xor_b32 v183, s52, v192
    v_lshl_add_u32 v183, v183, 4, s51
    v_lshlrev_b32 v193, 3, v192
    v_cvt_f32_u32 v193, v193
    v_mul_f32 v128, 0x3b000000, v193
    v_add_f32 v129, 0x3b000000, v128
    v_add_f32 v130, 0x3b800000, v128
    v_add_f32 v131, 0x3bc00000, v128
    v_add_f32 v132, 0x3c000000, v128
    v_add_f32 v133, 0x3c200000, v128
    v_add_f32 v134, 0x3c400000, v128
    v_add_f32 v135, 0x3c600000, v128
    s_and_b32 s52, s65, 3
    s_lshl_b32 s52, s52, 3
    s_lshl_b32 s53, s48, 5
    s_add_u32 s52, s52, s53
    s_cmp_lt_u32 s65, 4
    s_cselect_b32 s53, 0, 0x3e800000
    s_lshl_b32 s54, s48, 3
    s_add_u32 s54, s54, s65
    s_cmp_eq_u32 s54, 4
    s_cselect_b32 s55, 0x100, s52
    s_cselect_b32 s56, 0, s53
    v_cvt_f32_u32 v194, s55
    v_cvt_f32_u32 v195, s52
    v_cos_f32 v136, v128
    v_cos_f32 v137, v129
    v_cos_f32 v138, v130
    v_cos_f32 v139, v131
    v_cos_f32 v140, v132
    v_cos_f32 v141, v133
    v_cos_f32 v142, v134
    v_cos_f32 v143, v135
    v_fma_f32 v168, v128, v194, s56
    v_fma_f32 v169, v129, v194, s56
    v_fma_f32 v170, v130, v194, s56
    v_fma_f32 v171, v131, v194, s56
    v_fma_f32 v172, v132, v194, s56
    v_fma_f32 v173, v133, v194, s56
    v_fma_f32 v174, v134, v194, s56
    v_fma_f32 v175, v135, v194, s56
    v_fma_f32 v144, v128, v195, s53
    v_fma_f32 v145, v129, v195, s53
    v_fma_f32 v146, v130, v195, s53
    v_fma_f32 v147, v131, v195, s53
    v_fma_f32 v148, v132, v195, s53
    v_fma_f32 v149, v133, v195, s53
    v_fma_f32 v150, v134, v195, s53
    v_fma_f32 v151, v135, v195, s53
    v_add_f32 v152, v144, v128
    v_add_f32 v153, v145, v129
    v_add_f32 v154, v146, v130
    v_add_f32 v155, v147, v131
    v_add_f32 v156, v148, v132
    v_add_f32 v157, v149, v133
    v_add_f32 v158, v150, v134
    v_add_f32 v159, v151, v135
    v_cos_f32 v168, v168
    v_cos_f32 v169, v169
    v_cos_f32 v170, v170
    v_cos_f32 v171, v171
    v_cos_f32 v172, v172
    v_cos_f32 v173, v173
    v_cos_f32 v174, v174
    v_cos_f32 v175, v175
    v_cos_f32 v144, v144
    v_cos_f32 v145, v145
    v_cos_f32 v146, v146
    v_cos_f32 v147, v147
    v_cos_f32 v148, v148
    v_cos_f32 v149, v149
    v_cos_f32 v150, v150
    v_cos_f32 v151, v151
    v_cos_f32 v152, v152
    v_cos_f32 v153, v153
    v_cos_f32 v154, v154
    v_cos_f32 v155, v155
    v_cos_f32 v156, v156
    v_cos_f32 v157, v157
    v_cos_f32 v158, v158
    v_cos_f32 v159, v159
    v_add_f32 v136, v136, v136
    v_add_f32 v137, v137, v137
    v_add_f32 v138, v138, v138
    v_add_f32 v139, v139, v139
    v_add_f32 v140, v140, v140
    v_add_f32 v141, v141, v141
    v_add_f32 v142, v142, v142
    v_add_f32 v143, v143, v143
    s_setpc_b64 s[62:63]
KC_code_end:
.section .rodata,"a"
.p2align 6
.amdhsa_kernel adaLN_cond__spectral_fnet__geglu_ffn__prompt_kernel
  .amdhsa_next_free_vgpr 256
  .amdhsa_next_free_sgpr 102
  .amdhsa_accum_offset 256
  .amdhsa_group_segment_fixed_size 0
  .amdhsa_kernarg_size 112
  .amdhsa_user_sgpr_count 2
  .amdhsa_user_sgpr_kernarg_segment_ptr 1
  .amdhsa_system_sgpr_workgroup_id_x 1
.end_amdhsa_kernel
```
